```python
import torch

def _softmax(x, axis=-1):
    return torch.softmax(x, dim=axis)

def _gelu(x):
    return torch.nn.functional.gelu(x, approximate='tanh')

def _silu(x):
    return torch.nn.functional.silu(x)

def _sigmoid(x):
    return torch.sigmoid(x)

def _layernorm(x, axis=-1, eps=1e-05):
    m = x.mean(dim=axis, keepdim=True)
    v = x.var(dim=axis, keepdim=True, unbiased=False)
    return (x - m) / torch.sqrt(v + eps)

def _scatter_add(tgt, idx, src, axis=0):
    return tgt.clone().index_add_(axis, idx, src)

def _segment_sum(src, seg, n):
    out = torch.zeros((n,) + src.shape[1:], dtype=src.dtype)
    return out.index_add_(0, seg, src)

def _pad(x, pw):
    flat = tuple((v for pair in reversed(pw) for v in pair))
    return torch.nn.functional.pad(x, flat)
kernel_name = 'gated_mix__memory_aug_recurrent_mem_tr__sliding_block__prompt'

def setup_inputs():

    _w = lambda a: (lambda t: t.to(torch.bfloat16) if t.is_floating_point() else t)(torch.as_tensor(a))

    def _A_setup():
        B, S, Dm = (1, 2048, 512)
        H, Dh = (32, 128)
        M, seg = (8, 32)
        seg = min(seg, S)
        S = S // seg * seg
        return {'x': _w((lambda *s: torch.randn(*s, dtype=torch.bfloat16) * 0.05)(B, S, Dm)), 'mem0': _w((lambda *s: torch.randn(*s, dtype=torch.bfloat16) * 1.6)(B, M, Dm)), 'Wq': _w((lambda *s: torch.randn(*s, dtype=torch.bfloat16) * 0.8)(Dm, H, Dh) * Dm ** (-0.5)), 'Wk': _w((lambda *s: torch.randn(*s, dtype=torch.bfloat16) * 0.8)(Dm, H, Dh) * Dm ** (-0.5)), 'Wv': _w((lambda *s: torch.randn(*s, dtype=torch.bfloat16) * 1.6)(Dm, H, Dh) * Dm ** (-0.5)), 'Wo': _w((lambda *s: torch.randn(*s, dtype=torch.bfloat16) * 1.6)(H, Dh, Dm) * (H * Dh) ** (-0.5)), 'seg_len': seg}
    _A_in = _A_setup()

    def _B_setup():
        B, S, D = (1, 2048, 512)
        return {'x': _w((lambda *s: torch.randn(*s, dtype=torch.bfloat16) * 0.05)(B, S, D)), 'wqkv': _w((lambda *s: torch.randn(*s, dtype=torch.bfloat16) * 1.6)(D, 3 * D)), 'wo': _w((lambda *s: torch.randn(*s, dtype=torch.bfloat16) * 0.05)(D, D))}
    _B_in = _B_setup()
    return {'A_x': _A_in['x'], 'A_mem0': _A_in['mem0'], 'A_Wq': _A_in['Wq'], 'A_Wk': _A_in['Wk'], 'A_Wv': _A_in['Wv'], 'A_Wo': _A_in['Wo'], 'A_seg_len': _A_in['seg_len'], 'B_x': _B_in['x'], 'B_wqkv': _B_in['wqkv'], 'B_wo': _B_in['wo'], 'gate_w': _w((lambda *s: torch.randn(*s, dtype=torch.bfloat16) * 0.05)(512) * 16.0)}

def reference(A_x, A_mem0, A_Wq, A_Wk, A_Wv, A_Wo, A_seg_len, B_x, B_wqkv, B_wo, gate_w):

    def _A_ref(x, mem0, Wq, Wk, Wv, Wo, seg_len):
        B, S, Dm = x.shape
        H, Dh = (Wq.shape[1], Wq.shape[2])
        M = mem0.shape[1]
        scale = Dh ** (-0.5)
        n_seg = S // seg_len
        L = M + seg_len
        idx = torch.arange(L)
        mask = (idx[:, None] < M) | (idx[:, None] >= idx[None, :])
        mem = mem0
        outs = []
        for s in range(n_seg):
            xs = x[:, s * seg_len:(s + 1) * seg_len, :].clone()
            h = torch.concatenate([mem, xs], axis=1)
            q = torch.einsum('btd,dhe->bhte', h, Wq)
            k = torch.einsum('btd,dhe->bhte', h, Wk)
            v = torch.einsum('btd,dhe->bhte', h, Wv)
            scores = torch.einsum('bhqe,bhke->bhqk', q, k) * scale
            scores = torch.where(mask[None, None], scores, -1000000000.0)
            p = _softmax(scores, axis=-1)
            o = torch.einsum('bhqk,bhke->bhqe', p, v)
            o = torch.einsum('bhte,hed->btd', o, Wo)
            mem = o[:, :M, :].clone()
            outs.append(o[:, M:, :])
        return torch.concatenate(outs, axis=1)

    def _B_ref(x, wqkv, wo):
        B, S, D = x.shape
        H = 32
        Dh = D // H
        W = 256
        qkv = (lambda x, *d: x.permute(*d))((x @ wqkv).reshape(B, S, 3, H, Dh), 2, 0, 3, 1, 4)
        q, k, v = (qkv[0], qkv[1], qkv[2])
        scores = torch.einsum('bhqd,bhkd->bhqk', q, k) * Dh ** (-0.5)
        idx = torch.arange(S)
        mask = (idx[:, None] - idx[None, :] >= 0) & (idx[:, None] - idx[None, :] < W)
        scores = torch.where(mask[None, None], scores, -1000000000.0)
        p = _softmax(scores, axis=-1)
        o = torch.einsum('bhqk,bhkd->bhqd', p, v)
        return (lambda x, *d: x.permute(*d))(o, 0, 2, 1, 3).reshape(B, S, D) @ wo
    x = A_x
    g = _sigmoid((x * gate_w).sum(-1, keepdims=True))
    a = _A_ref(x, A_mem0, A_Wq, A_Wk, A_Wv, A_Wo, A_seg_len)
    b = _B_ref(x, B_wqkv, B_wo)
    return g * a + (1 - g) * b
```

```asm
; @launch grid=(256,1,1) block=(256,1,1) lds=163840
.amdgcn_target "amdgcn-amd-amdhsa--gfx950"
.text
.globl gated_mix__memory_aug_recurrent_mem_tr__sliding_block__prompt_kernel
.p2align 8
.type gated_mix__memory_aug_recurrent_mem_tr__sliding_block__prompt_kernel,@function
gated_mix__memory_aug_recurrent_mem_tr__sliding_block__prompt_kernel:
  s_load_dwordx16 s[64:79], s[0:1], 0
  s_load_dwordx8 s[80:87], s[0:1], 64
  s_load_dwordx4 s[88:91], s[0:1], 96
  s_getreg_b32 s50, hwreg(HW_REG_XCC_ID)
  s_and_b32 s50, s50, 7
  s_xor_b32 s50, s50, 1
  s_waitcnt lgkmcnt(0)
  s_mov_b32 s8, s90
  s_and_b32 s9, s91, 0xffff
  s_mov_b32 s10, 0x10000000
  s_mov_b32 s11, 0x00020000
  s_mov_b32 s32, s88
  s_and_b32 s33, s89, 0xffff
  s_mov_b32 s34, 0x100
  s_mov_b32 s35, 0x00020000
  s_lshl_b32 s55, s50, 2
  s_cselect_b32 s55, s55, 192
  v_mov_b32 v1, 0
  v_mov_b32 v2, 1
  v_cmp_eq_u32 vcc, 0, v0
  s_nop 0
  s_and_saveexec_b64 s[4:5], vcc
  s_cbranch_execz L_t0
  buffer_atomic_add v2, v1, s[32:35], s55 offen sc0 sc1
L_t0:
  s_mov_b64 exec, s[4:5]
  s_waitcnt vmcnt(0)
L_t3:
  s_and_saveexec_b64 s[4:5], vcc
  s_cbranch_execz L_t1
  ds_write_b32 v1, v2
  s_waitcnt lgkmcnt(0)
L_t1:
  s_mov_b64 exec, s[4:5]
  s_barrier
  ds_read_b32 v2, v1
  v_lshrrev_b32 v3, 6, v0
  s_waitcnt lgkmcnt(0)
  v_readfirstlane_b32 s51, v2
  v_readfirstlane_b32 s41, v3
  v_and_b32 v0, 63, v0
  s_barrier
  s_cmp_ge_u32 s51, 32
  s_cbranch_scc1 L_end
  v_lshlrev_b32 v1, 4, v0
  v_mov_b32 v8, -1
  v_mov_b32 v9, -1
  v_mov_b32 v10, -1
  v_mov_b32 v11, -1
  s_cmp_lg_u32 s50, 0
  s_cbranch_scc1 L_worker
  s_mov_b32 s40, s51
  s_mov_b32 s12, s68
  s_and_b32 s13, s69, 0xffff
  s_mov_b32 s14, 0x400000
  s_mov_b32 s15, 0x00020000
  s_mov_b32 s16, s70
  s_and_b32 s17, s71, 0xffff
  s_mov_b32 s18, 0x400000
  s_mov_b32 s19, 0x00020000
  s_mov_b32 s20, s72
  s_and_b32 s21, s73, 0xffff
  s_mov_b32 s22, 0x400000
  s_mov_b32 s23, 0x00020000
  s_mov_b32 s24, s74
  s_and_b32 s25, s75, 0xffff
  s_mov_b32 s26, 0x400000
  s_mov_b32 s27, 0x00020000
  s_mov_b32 s28, s66
  s_and_b32 s29, s67, 0xffff
  s_mov_b32 s30, 0x2000
  s_mov_b32 s31, 0x00020000
  v_lshlrev_b32 v24, 4, v0
  v_mov_b32 v28, -1
  v_mov_b32 v29, -1
  v_mov_b32 v30, -1
  v_mov_b32 v31, -1
  s_mul_i32 s55, s40, 10240
  s_lshl_b32 s56, s41, 11
  s_add_u32 s55, s55, s56
  s_add_u32 s55, s55, 0x4000000
  buffer_store_dwordx4 v[28:31], v24, s[8:11], s55 offen offset:0
  buffer_store_dwordx4 v[28:31], v24, s[8:11], s55 offen offset:1024
  s_lshl_b32 s55, s40, 10
  s_add_u32 s55, s55, 0x4080000
  buffer_store_dwordx4 v[28:31], v24, s[8:11], s55 offen
  s_lshl_b32 s55, s40, 8
  s_add_u32 s55, s55, s41
  s_lshl_b32 s55, s55, 10
  s_add_u32 s55, s55, 0x383f000
  buffer_store_dwordx4 v[28:31], v24, s[8:11], s55 offen sc1
  s_nop 1
  s_mul_i32 s57, s41, 36864
  s_add_u32 s57, s57, 16384
  v_lshrrev_b32 v7, 3, v0
  v_and_b32 v8, 7, v0
  v_lshlrev_b32 v8, 4, v8
  v_lshl_add_u32 v1, v7, 13, v8
  v_lshl_add_u32 v2, v7, 10, v8
  s_lshl_b32 s55, s40, 8
  s_lshr_b32 s56, s41, 1
  s_lshl_b32 s56, s56, 7
  s_add_u32 s55, s55, s56
  v_add_u32 v1, s55, v1
  s_lshl_b32 s55, s40, 17
  s_lshl_b32 s56, s41, 8
  s_add_u32 s55, s55, s56
  v_add_u32 v2, s55, v2
  v_bfe_u32 v51, v0, 5, 1
  v_lshlrev_b32 v51, 5, v51
  v_xor_b32 v1, v51, v1
  v_xor_b32 v48, 64, v1
  v_lshlrev_b32 v50, 13, v7
  v_bfe_u32 v51, v0, 1, 2
  v_lshl_add_u32 v50, v51, 8, v50
  v_and_b32 v51, 1, v0
  v_lshl_add_u32 v50, v51, 6, v50
  s_and_b32 s55, s40, 3
  s_lshl_b32 s55, s55, 16
  s_lshr_b32 s56, s40, 2
  s_lshl_b32 s56, s56, 10
  s_add_u32 s55, s55, s56
  s_lshr_b32 s56, s41, 1
  s_lshl_b32 s56, s56, 7
  s_add_u32 s55, s55, s56
  v_add_u32 v50, s55, v50
  s_xor_b32 s55, s41, 0
  s_lshl_b32 s55, s55, 15
  s_add_u32 s55, s55, 0
  s_add_u32 m0, s57, 0
  s_nop 0
  buffer_load_dwordx4 v2, s[24:27], s55 offen lds
  s_add_u32 s55, s55, 8192
  s_add_u32 m0, s57, 1024
  s_nop 0
  buffer_load_dwordx4 v2, s[24:27], s55 offen lds
  s_add_u32 s55, s55, 8192
  s_add_u32 m0, s57, 2048
  s_nop 0
  buffer_load_dwordx4 v2, s[24:27], s55 offen lds
  s_add_u32 s55, s55, 8192
  s_add_u32 m0, s57, 3072
  s_nop 0
  buffer_load_dwordx4 v2, s[24:27], s55 offen lds
  s_xor_b32 s55, s41, 1
  s_lshl_b32 s55, s55, 15
  s_add_u32 s55, s55, 0
  s_add_u32 m0, s57, 4096
  s_nop 0
  buffer_load_dwordx4 v2, s[24:27], s55 offen lds
  s_add_u32 s55, s55, 8192
  s_add_u32 m0, s57, 5120
  s_nop 0
  buffer_load_dwordx4 v2, s[24:27], s55 offen lds
  s_add_u32 s55, s55, 8192
  s_add_u32 m0, s57, 6144
  s_nop 0
  buffer_load_dwordx4 v2, s[24:27], s55 offen lds
  s_add_u32 s55, s55, 8192
  s_add_u32 m0, s57, 7168
  s_nop 0
  buffer_load_dwordx4 v2, s[24:27], s55 offen lds
  s_xor_b32 s55, s41, 0
  s_lshl_b32 s55, s55, 15
  s_add_u32 s55, s55, 128
  s_add_u32 m0, s57, 8192
  s_nop 0
  buffer_load_dwordx4 v2, s[24:27], s55 offen lds
  s_add_u32 s55, s55, 8192
  s_add_u32 m0, s57, 9216
  s_nop 0
  buffer_load_dwordx4 v2, s[24:27], s55 offen lds
  s_add_u32 s55, s55, 8192
  s_add_u32 m0, s57, 10240
  s_nop 0
  buffer_load_dwordx4 v2, s[24:27], s55 offen lds
  s_add_u32 s55, s55, 8192
  s_add_u32 m0, s57, 11264
  s_nop 0
  buffer_load_dwordx4 v2, s[24:27], s55 offen lds
  s_xor_b32 s55, s41, 1
  s_lshl_b32 s55, s55, 15
  s_add_u32 s55, s55, 128
  s_add_u32 m0, s57, 12288
  s_nop 0
  buffer_load_dwordx4 v2, s[24:27], s55 offen lds
  s_add_u32 s55, s55, 8192
  s_add_u32 m0, s57, 13312
  s_nop 0
  buffer_load_dwordx4 v2, s[24:27], s55 offen lds
  s_add_u32 s55, s55, 8192
  s_add_u32 m0, s57, 14336
  s_nop 0
  buffer_load_dwordx4 v2, s[24:27], s55 offen lds
  s_add_u32 s55, s55, 8192
  s_add_u32 m0, s57, 15360
  s_nop 0
  buffer_load_dwordx4 v2, s[24:27], s55 offen lds
  v_bfe_u32 v7, v0, 5, 1
  v_lshlrev_b32 v3, 4, v7
  v_lshlrev_b32 v5, 2, v7
  v_bfe_u32 v7, v0, 4, 1
  v_lshl_add_u32 v3, v7, 2, v3
  v_lshl_add_u32 v5, v7, 4, v5
  v_bfe_u32 v7, v0, 3, 1
  v_lshl_add_u32 v3, v7, 3, v3
  v_bfe_u32 v7, v0, 2, 1
  v_add_u32 v3, v7, v3
  v_bfe_u32 v7, v0, 2, 2
  v_add_u32 v5, v5, v7
  v_and_b32 v7, 3, v0
  v_lshlrev_b32 v3, 7, v3
  v_lshl_add_u32 v3, v7, 3, v3
  v_lshlrev_b32 v5, 7, v5
  v_lshl_add_u32 v5, v7, 3, v5
  v_add_u32 v5, s57, v5
  s_and_b32 s55, s41, 1
  s_lshl_b32 s55, s55, 6
  v_add_u32 v3, s55, v3
  v_bfe_u32 v7, v0, 4, 1
  v_lshlrev_b32 v7, 5, v7
  v_xor_b32 v3, v7, v3
  v_bfe_u32 v7, v0, 3, 1
  v_lshlrev_b32 v7, 6, v7
  v_xor_b32 v3, v7, v3
  s_xor_b32 s55, s41, 1
  s_mul_i32 s55, s55, 36864
  s_add_u32 s55, s55, 16384
  v_add_u32 v4, s55, v3
  v_add_u32 v3, s57, v3
  v_xor_b32 v49, 32, v3
  v_xor_b32 v52, 32, v4
  v_lshlrev_b32 v6, 4, v0
  v_add_u32 v6, s57, v6
  s_waitcnt vmcnt(16)
  s_barrier
  s_cmp_lg_u32 s41, 0
  s_cbranch_scc1 L_ra_1
  v_mov_b32 v58, 64
  v_mov_b32 v59, 1
  s_mov_b64 exec, 1
  buffer_atomic_add v59, v58, s[32:35], 0 offen sc1
  s_mov_b64 exec, -1
L_ra_1:
  v_and_b32 v56, 7, v0
  v_lshlrev_b32 v57, 10, v56
  v_lshrrev_b32 v56, 4, v0
  v_lshl_add_u32 v57, v56, 5, v57
  v_bfe_u32 v56, v0, 3, 1
  v_lshl_add_u32 v57, v56, 4, v57
  s_lshl_b32 s55, s41, 8
  buffer_load_dwordx4 v[32:35], v57, s[28:31], s55 offen offset:0
  buffer_load_dwordx4 v[36:39], v57, s[28:31], s55 offen offset:128
  s_lshl_b32 s44, s40, 20
  s_lshl_b32 s55, s41, 12
  s_add_u32 s44, s44, s55
  s_mov_b32 s42, 0
  s_waitcnt vmcnt(14)
  ds_read_b64_tr_b16 v[8:9], v5 offset:0
  ds_read_b64_tr_b16 v[10:11], v5 offset:32
  ds_read_b64_tr_b16 v[12:13], v5 offset:1024
  ds_read_b64_tr_b16 v[14:15], v5 offset:1056
  ds_read_b64_tr_b16 v[16:17], v5 offset:64
  ds_read_b64_tr_b16 v[18:19], v5 offset:96
  ds_read_b64_tr_b16 v[20:21], v5 offset:1088
  ds_read_b64_tr_b16 v[22:23], v5 offset:1120
  s_xor_b32 s55, s41, 2
  s_lshl_b32 s55, s55, 15
  s_add_u32 s55, s55, 0
  s_add_u32 m0, s57, 16384
  s_nop 0
  buffer_load_dwordx4 v2, s[24:27], s55 offen lds
  s_add_u32 s55, s55, 8192
  s_add_u32 m0, s57, 17408
  s_nop 0
  buffer_load_dwordx4 v2, s[24:27], s55 offen lds
  s_add_u32 s55, s55, 8192
  s_add_u32 m0, s57, 18432
  s_nop 0
  buffer_load_dwordx4 v2, s[24:27], s55 offen lds
  s_add_u32 s55, s55, 8192
  s_add_u32 m0, s57, 19456
  s_nop 0
  buffer_load_dwordx4 v2, s[24:27], s55 offen lds
  s_waitcnt lgkmcnt(0)
  v_mov_b32 v160, v8
  v_mov_b32 v162, v9
  v_mov_b32 v161, v10
  v_mov_b32 v163, v11
  v_mov_b32 v164, v12
  v_mov_b32 v166, v13
  v_mov_b32 v165, v14
  v_mov_b32 v167, v15
  v_mov_b32 v192, v16
  v_mov_b32 v194, v17
  v_mov_b32 v193, v18
  v_mov_b32 v195, v19
  v_mov_b32 v196, v20
  v_mov_b32 v198, v21
  v_mov_b32 v197, v22
  v_mov_b32 v199, v23
  s_waitcnt vmcnt(14)
  ds_read_b64_tr_b16 v[8:9], v5 offset:4096
  ds_read_b64_tr_b16 v[10:11], v5 offset:4128
  ds_read_b64_tr_b16 v[12:13], v5 offset:5120
  ds_read_b64_tr_b16 v[14:15], v5 offset:5152
  ds_read_b64_tr_b16 v[16:17], v5 offset:4160
  ds_read_b64_tr_b16 v[18:19], v5 offset:4192
  ds_read_b64_tr_b16 v[20:21], v5 offset:5184
  ds_read_b64_tr_b16 v[22:23], v5 offset:5216
  s_xor_b32 s55, s41, 3
  s_lshl_b32 s55, s55, 15
  s_add_u32 s55, s55, 0
  s_add_u32 m0, s57, 20480
  s_nop 0
  buffer_load_dwordx4 v2, s[24:27], s55 offen lds
  s_add_u32 s55, s55, 8192
  s_add_u32 m0, s57, 21504
  s_nop 0
  buffer_load_dwordx4 v2, s[24:27], s55 offen lds
  s_add_u32 s55, s55, 8192
  s_add_u32 m0, s57, 22528
  s_nop 0
  buffer_load_dwordx4 v2, s[24:27], s55 offen lds
  s_add_u32 s55, s55, 8192
  s_add_u32 m0, s57, 23552
  s_nop 0
  buffer_load_dwordx4 v2, s[24:27], s55 offen lds
  s_waitcnt lgkmcnt(0)
  v_mov_b32 v168, v8
  v_mov_b32 v170, v9
  v_mov_b32 v169, v10
  v_mov_b32 v171, v11
  v_mov_b32 v172, v12
  v_mov_b32 v174, v13
  v_mov_b32 v173, v14
  v_mov_b32 v175, v15
  v_mov_b32 v200, v16
  v_mov_b32 v202, v17
  v_mov_b32 v201, v18
  v_mov_b32 v203, v19
  v_mov_b32 v204, v20
  v_mov_b32 v206, v21
  v_mov_b32 v205, v22
  v_mov_b32 v207, v23
  s_waitcnt vmcnt(14)
  ds_read_b64_tr_b16 v[8:9], v5 offset:8192
  ds_read_b64_tr_b16 v[10:11], v5 offset:8224
  ds_read_b64_tr_b16 v[12:13], v5 offset:9216
  ds_read_b64_tr_b16 v[14:15], v5 offset:9248
  ds_read_b64_tr_b16 v[16:17], v5 offset:8256
  ds_read_b64_tr_b16 v[18:19], v5 offset:8288
  ds_read_b64_tr_b16 v[20:21], v5 offset:9280
  ds_read_b64_tr_b16 v[22:23], v5 offset:9312
  s_xor_b32 s55, s41, 2
  s_lshl_b32 s55, s55, 15
  s_add_u32 s55, s55, 128
  s_add_u32 m0, s57, 24576
  s_nop 0
  buffer_load_dwordx4 v2, s[24:27], s55 offen lds
  s_add_u32 s55, s55, 8192
  s_add_u32 m0, s57, 25600
  s_nop 0
  buffer_load_dwordx4 v2, s[24:27], s55 offen lds
  s_add_u32 s55, s55, 8192
  s_add_u32 m0, s57, 26624
  s_nop 0
  buffer_load_dwordx4 v2, s[24:27], s55 offen lds
  s_add_u32 s55, s55, 8192
  s_add_u32 m0, s57, 27648
  s_nop 0
  buffer_load_dwordx4 v2, s[24:27], s55 offen lds
  s_waitcnt lgkmcnt(0)
  v_mov_b32 v24, v8
  v_mov_b32 v26, v9
  v_mov_b32 v25, v10
  v_mov_b32 v27, v11
  v_mov_b32 v28, v12
  v_mov_b32 v30, v13
  v_mov_b32 v29, v14
  v_mov_b32 v31, v15
  v_mov_b32 v232, v16
  v_mov_b32 v234, v17
  v_mov_b32 v233, v18
  v_mov_b32 v235, v19
  v_mov_b32 v236, v20
  v_mov_b32 v238, v21
  v_mov_b32 v237, v22
  v_mov_b32 v239, v23
  s_waitcnt vmcnt(14)
  ds_read_b64_tr_b16 v[8:9], v5 offset:12288
  ds_read_b64_tr_b16 v[10:11], v5 offset:12320
  ds_read_b64_tr_b16 v[12:13], v5 offset:13312
  ds_read_b64_tr_b16 v[14:15], v5 offset:13344
  ds_read_b64_tr_b16 v[16:17], v5 offset:12352
  ds_read_b64_tr_b16 v[18:19], v5 offset:12384
  ds_read_b64_tr_b16 v[20:21], v5 offset:13376
  ds_read_b64_tr_b16 v[22:23], v5 offset:13408
  s_xor_b32 s55, s41, 3
  s_lshl_b32 s55, s55, 15
  s_add_u32 s55, s55, 128
  s_add_u32 m0, s57, 28672
  s_nop 0
  buffer_load_dwordx4 v2, s[24:27], s55 offen lds
  s_add_u32 s55, s55, 8192
  s_add_u32 m0, s57, 29696
  s_nop 0
  buffer_load_dwordx4 v2, s[24:27], s55 offen lds
  s_add_u32 s55, s55, 8192
  s_add_u32 m0, s57, 30720
  s_nop 0
  buffer_load_dwordx4 v2, s[24:27], s55 offen lds
  s_add_u32 s55, s55, 8192
  s_add_u32 m0, s57, 31744
  s_nop 0
  buffer_load_dwordx4 v2, s[24:27], s55 offen lds
  s_waitcnt lgkmcnt(0)
  v_mov_b32 v40, v8
  v_mov_b32 v42, v9
  v_mov_b32 v41, v10
  v_mov_b32 v43, v11
  v_mov_b32 v44, v12
  v_mov_b32 v46, v13
  v_mov_b32 v45, v14
  v_mov_b32 v47, v15
  v_mov_b32 v240, v16
  v_mov_b32 v242, v17
  v_mov_b32 v241, v18
  v_mov_b32 v243, v19
  v_mov_b32 v244, v20
  v_mov_b32 v246, v21
  v_mov_b32 v245, v22
  v_mov_b32 v247, v23
  s_waitcnt vmcnt(12)
  ds_read_b64_tr_b16 v[8:9], v5 offset:16384
  ds_read_b64_tr_b16 v[10:11], v5 offset:16416
  ds_read_b64_tr_b16 v[12:13], v5 offset:17408
  ds_read_b64_tr_b16 v[14:15], v5 offset:17440
  ds_read_b64_tr_b16 v[16:17], v5 offset:16448
  ds_read_b64_tr_b16 v[18:19], v5 offset:16480
  ds_read_b64_tr_b16 v[20:21], v5 offset:17472
  ds_read_b64_tr_b16 v[22:23], v5 offset:17504
  s_lshl_b32 s55, s41, 2
  s_xor_b32 s55, s55, 10
  s_lshl_b32 s55, s55, 18
  s_add_u32 m0, s57, 32768
  s_nop 0
  buffer_load_dwordx4 v1, s[20:23], s55 offen lds
  s_add_u32 s55, s55, 65536
  s_add_u32 m0, s57, 33792
  s_nop 0
  buffer_load_dwordx4 v48, s[20:23], s55 offen lds
  s_add_u32 s55, s55, 65536
  s_add_u32 m0, s57, 34816
  s_nop 0
  buffer_load_dwordx4 v1, s[20:23], s55 offen lds
  s_add_u32 s55, s55, 65536
  s_add_u32 m0, s57, 35840
  s_nop 0
  buffer_load_dwordx4 v48, s[20:23], s55 offen lds
  s_waitcnt lgkmcnt(0)
  v_mov_b32 v176, v8
  v_mov_b32 v178, v9
  v_mov_b32 v177, v10
  v_mov_b32 v179, v11
  v_mov_b32 v180, v12
  v_mov_b32 v182, v13
  v_mov_b32 v181, v14
  v_mov_b32 v183, v15
  v_mov_b32 v88, v16
  v_mov_b32 v90, v17
  v_mov_b32 v89, v18
  v_mov_b32 v91, v19
  v_mov_b32 v92, v20
  v_mov_b32 v94, v21
  v_mov_b32 v93, v22
  v_mov_b32 v95, v23
  s_waitcnt vmcnt(12)
  ds_read_b64_tr_b16 v[8:9], v5 offset:20480
  ds_read_b64_tr_b16 v[10:11], v5 offset:20512
  ds_read_b64_tr_b16 v[12:13], v5 offset:21504
  ds_read_b64_tr_b16 v[14:15], v5 offset:21536
  ds_read_b64_tr_b16 v[16:17], v5 offset:20544
  ds_read_b64_tr_b16 v[18:19], v5 offset:20576
  ds_read_b64_tr_b16 v[20:21], v5 offset:21568
  ds_read_b64_tr_b16 v[22:23], v5 offset:21600
  s_lshl_b32 s55, s41, 2
  s_xor_b32 s55, s55, 11
  s_lshl_b32 s55, s55, 18
  s_add_u32 m0, s57, 0
  s_nop 0
  buffer_load_dwordx4 v1, s[20:23], s55 offen lds
  s_add_u32 s55, s55, 65536
  s_add_u32 m0, s57, 1024
  s_nop 0
  buffer_load_dwordx4 v48, s[20:23], s55 offen lds
  s_add_u32 s55, s55, 65536
  s_add_u32 m0, s57, 2048
  s_nop 0
  buffer_load_dwordx4 v1, s[20:23], s55 offen lds
  s_add_u32 s55, s55, 65536
  s_add_u32 m0, s57, 3072
  s_nop 0
  buffer_load_dwordx4 v48, s[20:23], s55 offen lds
  s_waitcnt lgkmcnt(0)
  v_mov_b32 v184, v8
  v_mov_b32 v186, v9
  v_mov_b32 v185, v10
  v_mov_b32 v187, v11
  v_mov_b32 v188, v12
  v_mov_b32 v190, v13
  v_mov_b32 v189, v14
  v_mov_b32 v191, v15
  v_mov_b32 v208, v16
  v_mov_b32 v210, v17
  v_mov_b32 v209, v18
  v_mov_b32 v211, v19
  v_mov_b32 v212, v20
  v_mov_b32 v214, v21
  v_mov_b32 v213, v22
  v_mov_b32 v215, v23
  s_waitcnt vmcnt(12)
  ds_read_b64_tr_b16 v[8:9], v5 offset:24576
  ds_read_b64_tr_b16 v[10:11], v5 offset:24608
  ds_read_b64_tr_b16 v[12:13], v5 offset:25600
  ds_read_b64_tr_b16 v[14:15], v5 offset:25632
  ds_read_b64_tr_b16 v[16:17], v5 offset:24640
  ds_read_b64_tr_b16 v[18:19], v5 offset:24672
  ds_read_b64_tr_b16 v[20:21], v5 offset:25664
  ds_read_b64_tr_b16 v[22:23], v5 offset:25696
  s_lshl_b32 s55, s41, 2
  s_xor_b32 s55, s55, 2
  s_lshl_b32 s55, s55, 18
  s_add_u32 m0, s57, 4096
  s_nop 0
  buffer_load_dwordx4 v1, s[20:23], s55 offen lds
  s_add_u32 s55, s55, 65536
  s_add_u32 m0, s57, 5120
  s_nop 0
  buffer_load_dwordx4 v48, s[20:23], s55 offen lds
  s_add_u32 s55, s55, 65536
  s_add_u32 m0, s57, 6144
  s_nop 0
  buffer_load_dwordx4 v1, s[20:23], s55 offen lds
  s_add_u32 s55, s55, 65536
  s_add_u32 m0, s57, 7168
  s_nop 0
  buffer_load_dwordx4 v48, s[20:23], s55 offen lds
  s_waitcnt lgkmcnt(0)
  v_mov_b32 v216, v8
  v_mov_b32 v218, v9
  v_mov_b32 v217, v10
  v_mov_b32 v219, v11
  v_mov_b32 v220, v12
  v_mov_b32 v222, v13
  v_mov_b32 v221, v14
  v_mov_b32 v223, v15
  v_mov_b32 v248, v16
  v_mov_b32 v250, v17
  v_mov_b32 v249, v18
  v_mov_b32 v251, v19
  v_mov_b32 v252, v20
  v_mov_b32 v254, v21
  v_mov_b32 v253, v22
  v_mov_b32 v255, v23
  s_waitcnt vmcnt(12)
  ds_read_b64_tr_b16 v[8:9], v5 offset:28672
  ds_read_b64_tr_b16 v[10:11], v5 offset:28704
  ds_read_b64_tr_b16 v[12:13], v5 offset:29696
  ds_read_b64_tr_b16 v[14:15], v5 offset:29728
  ds_read_b64_tr_b16 v[16:17], v5 offset:28736
  ds_read_b64_tr_b16 v[18:19], v5 offset:28768
  ds_read_b64_tr_b16 v[20:21], v5 offset:29760
  ds_read_b64_tr_b16 v[22:23], v5 offset:29792
  s_lshl_b32 s55, s41, 2
  s_xor_b32 s55, s55, 3
  s_lshl_b32 s55, s55, 18
  s_add_u32 m0, s57, 8192
  s_nop 0
  buffer_load_dwordx4 v1, s[20:23], s55 offen lds
  s_add_u32 s55, s55, 65536
  s_add_u32 m0, s57, 9216
  s_nop 0
  buffer_load_dwordx4 v48, s[20:23], s55 offen lds
  s_add_u32 s55, s55, 65536
  s_add_u32 m0, s57, 10240
  s_nop 0
  buffer_load_dwordx4 v1, s[20:23], s55 offen lds
  s_add_u32 s55, s55, 65536
  s_add_u32 m0, s57, 11264
  s_nop 0
  buffer_load_dwordx4 v48, s[20:23], s55 offen lds
  s_waitcnt lgkmcnt(0)
  v_mov_b32 v224, v8
  v_mov_b32 v226, v9
  v_mov_b32 v225, v10
  v_mov_b32 v227, v11
  v_mov_b32 v228, v12
  v_mov_b32 v230, v13
  v_mov_b32 v229, v14
  v_mov_b32 v231, v15
  v_mov_b32 v96, v16
  v_mov_b32 v98, v17
  v_mov_b32 v97, v18
  v_mov_b32 v99, v19
  v_mov_b32 v100, v20
  v_mov_b32 v102, v21
  v_mov_b32 v101, v22
  v_mov_b32 v103, v23
  s_waitcnt vmcnt(12)
  s_barrier
  ds_read_b64_tr_b16 a[224:225], v3 offset:32768
  ds_read_b64_tr_b16 a[226:227], v3 offset:33024
  ds_read_b64_tr_b16 a[232:233], v49 offset:32768
  ds_read_b64_tr_b16 a[234:235], v49 offset:33024
  ds_read_b64_tr_b16 v[144:145], v4 offset:32768
  ds_read_b64_tr_b16 v[146:147], v4 offset:33024
  ds_read_b64_tr_b16 v[152:153], v52 offset:32768
  ds_read_b64_tr_b16 v[154:155], v52 offset:33024
  s_lshl_b32 s55, s41, 2
  s_xor_b32 s55, s55, 8
  s_lshl_b32 s55, s55, 18
  s_add_u32 m0, s57, 12288
  s_nop 0
  buffer_load_dwordx4 v1, s[20:23], s55 offen lds
  s_add_u32 s55, s55, 65536
  s_add_u32 m0, s57, 13312
  s_nop 0
  buffer_load_dwordx4 v48, s[20:23], s55 offen lds
  s_add_u32 s55, s55, 65536
  s_add_u32 m0, s57, 14336
  s_nop 0
  buffer_load_dwordx4 v1, s[20:23], s55 offen lds
  s_add_u32 s55, s55, 65536
  s_add_u32 m0, s57, 15360
  s_nop 0
  buffer_load_dwordx4 v48, s[20:23], s55 offen lds
  s_waitcnt lgkmcnt(0)
  s_waitcnt vmcnt(12)
  s_barrier
  ds_read_b64_tr_b16 a[228:229], v3 offset:0
  ds_read_b64_tr_b16 a[230:231], v3 offset:256
  ds_read_b64_tr_b16 a[236:237], v49 offset:0
  ds_read_b64_tr_b16 a[238:239], v49 offset:256
  ds_read_b64_tr_b16 v[148:149], v4 offset:0
  ds_read_b64_tr_b16 v[150:151], v4 offset:256
  ds_read_b64_tr_b16 v[156:157], v52 offset:0
  ds_read_b64_tr_b16 v[158:159], v52 offset:256
  s_lshl_b32 s55, s41, 2
  s_xor_b32 s55, s55, 9
  s_lshl_b32 s55, s55, 18
  s_add_u32 m0, s57, 16384
  s_nop 0
  buffer_load_dwordx4 v1, s[20:23], s55 offen lds
  s_add_u32 s55, s55, 65536
  s_add_u32 m0, s57, 17408
  s_nop 0
  buffer_load_dwordx4 v48, s[20:23], s55 offen lds
  s_add_u32 s55, s55, 65536
  s_add_u32 m0, s57, 18432
  s_nop 0
  buffer_load_dwordx4 v1, s[20:23], s55 offen lds
  s_add_u32 s55, s55, 65536
  s_add_u32 m0, s57, 19456
  s_nop 0
  buffer_load_dwordx4 v48, s[20:23], s55 offen lds
  s_waitcnt lgkmcnt(0)
  s_waitcnt vmcnt(12)
  s_barrier
  ds_read_b64_tr_b16 a[184:185], v3 offset:4096
  ds_read_b64_tr_b16 a[186:187], v3 offset:4352
  ds_read_b64_tr_b16 a[192:193], v49 offset:4096
  ds_read_b64_tr_b16 a[194:195], v49 offset:4352
  ds_read_b64_tr_b16 v[104:105], v4 offset:4096
  ds_read_b64_tr_b16 v[106:107], v4 offset:4352
  ds_read_b64_tr_b16 a[208:209], v52 offset:4096
  ds_read_b64_tr_b16 a[210:211], v52 offset:4352
  s_lshl_b32 s55, s41, 2
  s_xor_b32 s55, s55, 10
  s_lshl_b32 s55, s55, 18
  s_add_u32 m0, s57, 20480
  s_nop 0
  buffer_load_dwordx4 v1, s[16:19], s55 offen lds
  s_add_u32 s55, s55, 65536
  s_add_u32 m0, s57, 21504
  s_nop 0
  buffer_load_dwordx4 v48, s[16:19], s55 offen lds
  s_add_u32 s55, s55, 65536
  s_add_u32 m0, s57, 22528
  s_nop 0
  buffer_load_dwordx4 v1, s[16:19], s55 offen lds
  s_add_u32 s55, s55, 65536
  s_add_u32 m0, s57, 23552
  s_nop 0
  buffer_load_dwordx4 v48, s[16:19], s55 offen lds
  s_waitcnt lgkmcnt(0)
  s_waitcnt vmcnt(12)
  s_barrier
  ds_read_b64_tr_b16 a[188:189], v3 offset:8192
  ds_read_b64_tr_b16 a[190:191], v3 offset:8448
  ds_read_b64_tr_b16 a[196:197], v49 offset:8192
  ds_read_b64_tr_b16 a[198:199], v49 offset:8448
  ds_read_b64_tr_b16 v[108:109], v4 offset:8192
  ds_read_b64_tr_b16 v[110:111], v4 offset:8448
  ds_read_b64_tr_b16 a[212:213], v52 offset:8192
  ds_read_b64_tr_b16 a[214:215], v52 offset:8448
  s_lshl_b32 s55, s41, 2
  s_xor_b32 s55, s55, 11
  s_lshl_b32 s55, s55, 18
  s_add_u32 m0, s57, 24576
  s_nop 0
  buffer_load_dwordx4 v1, s[16:19], s55 offen lds
  s_add_u32 s55, s55, 65536
  s_add_u32 m0, s57, 25600
  s_nop 0
  buffer_load_dwordx4 v48, s[16:19], s55 offen lds
  s_add_u32 s55, s55, 65536
  s_add_u32 m0, s57, 26624
  s_nop 0
  buffer_load_dwordx4 v1, s[16:19], s55 offen lds
  s_add_u32 s55, s55, 65536
  s_add_u32 m0, s57, 27648
  s_nop 0
  buffer_load_dwordx4 v48, s[16:19], s55 offen lds
  s_waitcnt lgkmcnt(0)
  s_waitcnt vmcnt(12)
  s_barrier
  ds_read_b64_tr_b16 v[112:113], v3 offset:12288
  ds_read_b64_tr_b16 v[114:115], v3 offset:12544
  ds_read_b64_tr_b16 a[216:217], v49 offset:12288
  ds_read_b64_tr_b16 a[218:219], v49 offset:12544
  ds_read_b64_tr_b16 a[240:241], v4 offset:12288
  ds_read_b64_tr_b16 a[242:243], v4 offset:12544
  ds_read_b64_tr_b16 a[248:249], v52 offset:12288
  ds_read_b64_tr_b16 a[250:251], v52 offset:12544
  s_lshl_b32 s55, s41, 2
  s_xor_b32 s55, s55, 10
  s_lshl_b32 s55, s55, 18
  s_add_u32 m0, s57, 28672
  s_nop 0
  buffer_load_dwordx4 v1, s[12:15], s55 offen lds
  s_add_u32 s55, s55, 65536
  s_add_u32 m0, s57, 29696
  s_nop 0
  buffer_load_dwordx4 v48, s[12:15], s55 offen lds
  s_add_u32 s55, s55, 65536
  s_add_u32 m0, s57, 30720
  s_nop 0
  buffer_load_dwordx4 v1, s[12:15], s55 offen lds
  s_add_u32 s55, s55, 65536
  s_add_u32 m0, s57, 31744
  s_nop 0
  buffer_load_dwordx4 v48, s[12:15], s55 offen lds
  s_waitcnt lgkmcnt(0)
  s_waitcnt vmcnt(12)
  s_barrier
  ds_read_b64_tr_b16 v[116:117], v3 offset:16384
  ds_read_b64_tr_b16 v[118:119], v3 offset:16640
  ds_read_b64_tr_b16 a[220:221], v49 offset:16384
  ds_read_b64_tr_b16 a[222:223], v49 offset:16640
  ds_read_b64_tr_b16 a[244:245], v4 offset:16384
  ds_read_b64_tr_b16 a[246:247], v4 offset:16640
  ds_read_b64_tr_b16 a[252:253], v52 offset:16384
  ds_read_b64_tr_b16 a[254:255], v52 offset:16640
  s_lshl_b32 s55, s41, 2
  s_xor_b32 s55, s55, 11
  s_lshl_b32 s55, s55, 18
  s_add_u32 m0, s57, 32768
  s_nop 0
  buffer_load_dwordx4 v1, s[12:15], s55 offen lds
  s_add_u32 s55, s55, 65536
  s_add_u32 m0, s57, 33792
  s_nop 0
  buffer_load_dwordx4 v48, s[12:15], s55 offen lds
  s_add_u32 s55, s55, 65536
  s_add_u32 m0, s57, 34816
  s_nop 0
  buffer_load_dwordx4 v1, s[12:15], s55 offen lds
  s_add_u32 s55, s55, 65536
  s_add_u32 m0, s57, 35840
  s_nop 0
  buffer_load_dwordx4 v48, s[12:15], s55 offen lds
  s_waitcnt lgkmcnt(0)
  s_waitcnt vmcnt(12)
  s_barrier
  ds_read_b64_tr_b16 a[136:137], v3 offset:20480
  ds_read_b64_tr_b16 a[138:139], v3 offset:20736
  ds_read_b64_tr_b16 a[144:145], v49 offset:20480
  ds_read_b64_tr_b16 a[146:147], v49 offset:20736
  ds_read_b64_tr_b16 v[120:121], v4 offset:20480
  ds_read_b64_tr_b16 v[122:123], v4 offset:20736
  ds_read_b64_tr_b16 a[160:161], v52 offset:20480
  ds_read_b64_tr_b16 a[162:163], v52 offset:20736
  s_lshl_b32 s55, s41, 2
  s_xor_b32 s55, s55, 0
  s_lshl_b32 s55, s55, 18
  s_add_u32 m0, s57, 0
  s_nop 0
  buffer_load_dwordx4 v1, s[20:23], s55 offen lds
  s_add_u32 s55, s55, 65536
  s_add_u32 m0, s57, 1024
  s_nop 0
  buffer_load_dwordx4 v48, s[20:23], s55 offen lds
  s_add_u32 s55, s55, 65536
  s_add_u32 m0, s57, 2048
  s_nop 0
  buffer_load_dwordx4 v1, s[20:23], s55 offen lds
  s_add_u32 s55, s55, 65536
  s_add_u32 m0, s57, 3072
  s_nop 0
  buffer_load_dwordx4 v48, s[20:23], s55 offen lds
  s_waitcnt lgkmcnt(0)
  v_mov_b32 v58, 64
  buffer_load_dword v58, v58, s[32:35], 0 offen sc1
  s_waitcnt vmcnt(13)
  s_barrier
  ds_read_b64_tr_b16 a[140:141], v3 offset:24576
  ds_read_b64_tr_b16 a[142:143], v3 offset:24832
  ds_read_b64_tr_b16 a[148:149], v49 offset:24576
  ds_read_b64_tr_b16 a[150:151], v49 offset:24832
  ds_read_b64_tr_b16 v[124:125], v4 offset:24576
  ds_read_b64_tr_b16 v[126:127], v4 offset:24832
  ds_read_b64_tr_b16 a[164:165], v52 offset:24576
  ds_read_b64_tr_b16 a[166:167], v52 offset:24832
  s_lshl_b32 s55, s41, 2
  s_xor_b32 s55, s55, 1
  s_lshl_b32 s55, s55, 18
  s_add_u32 m0, s57, 4096
  s_nop 0
  buffer_load_dwordx4 v1, s[20:23], s55 offen lds
  s_add_u32 s55, s55, 65536
  s_add_u32 m0, s57, 5120
  s_nop 0
  buffer_load_dwordx4 v48, s[20:23], s55 offen lds
  s_add_u32 s55, s55, 65536
  s_add_u32 m0, s57, 6144
  s_nop 0
  buffer_load_dwordx4 v1, s[20:23], s55 offen lds
  s_add_u32 s55, s55, 65536
  s_add_u32 m0, s57, 7168
  s_nop 0
  buffer_load_dwordx4 v48, s[20:23], s55 offen lds
  s_waitcnt lgkmcnt(0)
  s_waitcnt vmcnt(13)
  s_barrier
  ds_read_b64_tr_b16 a[48:49], v3 offset:28672
  ds_read_b64_tr_b16 a[50:51], v3 offset:28928
  ds_read_b64_tr_b16 a[56:57], v49 offset:28672
  ds_read_b64_tr_b16 a[58:59], v49 offset:28928
  ds_read_b64_tr_b16 v[128:129], v4 offset:28672
  ds_read_b64_tr_b16 v[130:131], v4 offset:28928
  ds_read_b64_tr_b16 a[72:73], v52 offset:28672
  ds_read_b64_tr_b16 a[74:75], v52 offset:28928
  s_lshl_b32 s55, s41, 2
  s_xor_b32 s55, s55, 8
  s_lshl_b32 s55, s55, 18
  s_add_u32 m0, s57, 8192
  s_nop 0
  buffer_load_dwordx4 v1, s[16:19], s55 offen lds
  s_add_u32 s55, s55, 65536
  s_add_u32 m0, s57, 9216
  s_nop 0
  buffer_load_dwordx4 v48, s[16:19], s55 offen lds
  s_add_u32 s55, s55, 65536
  s_add_u32 m0, s57, 10240
  s_nop 0
  buffer_load_dwordx4 v1, s[16:19], s55 offen lds
  s_add_u32 s55, s55, 65536
  s_add_u32 m0, s57, 11264
  s_nop 0
  buffer_load_dwordx4 v48, s[16:19], s55 offen lds
  s_waitcnt lgkmcnt(0)
  s_waitcnt vmcnt(13)
  s_barrier
  ds_read_b64_tr_b16 a[52:53], v3 offset:32768
  ds_read_b64_tr_b16 a[54:55], v3 offset:33024
  ds_read_b64_tr_b16 a[60:61], v49 offset:32768
  ds_read_b64_tr_b16 a[62:63], v49 offset:33024
  ds_read_b64_tr_b16 v[132:133], v4 offset:32768
  ds_read_b64_tr_b16 v[134:135], v4 offset:33024
  ds_read_b64_tr_b16 a[76:77], v52 offset:32768
  ds_read_b64_tr_b16 a[78:79], v52 offset:33024
  s_lshl_b32 s55, s41, 2
  s_xor_b32 s55, s55, 9
  s_lshl_b32 s55, s55, 18
  s_add_u32 m0, s57, 12288
  s_nop 0
  buffer_load_dwordx4 v1, s[16:19], s55 offen lds
  s_add_u32 s55, s55, 65536
  s_add_u32 m0, s57, 13312
  s_nop 0
  buffer_load_dwordx4 v48, s[16:19], s55 offen lds
  s_add_u32 s55, s55, 65536
  s_add_u32 m0, s57, 14336
  s_nop 0
  buffer_load_dwordx4 v1, s[16:19], s55 offen lds
  s_add_u32 s55, s55, 65536
  s_add_u32 m0, s57, 15360
  s_nop 0
  buffer_load_dwordx4 v48, s[16:19], s55 offen lds
  s_waitcnt lgkmcnt(0)
  s_waitcnt vmcnt(13)
  s_barrier
  ds_read_b64_tr_b16 a[168:169], v3 offset:0
  ds_read_b64_tr_b16 a[170:171], v3 offset:256
  ds_read_b64_tr_b16 a[176:177], v49 offset:0
  ds_read_b64_tr_b16 a[178:179], v49 offset:256
  ds_read_b64_tr_b16 v[136:137], v4 offset:0
  ds_read_b64_tr_b16 v[138:139], v4 offset:256
  ds_read_b64_tr_b16 a[200:201], v52 offset:0
  ds_read_b64_tr_b16 a[202:203], v52 offset:256
  s_lshl_b32 s55, s41, 2
  s_xor_b32 s55, s55, 8
  s_lshl_b32 s55, s55, 18
  s_add_u32 m0, s57, 16384
  s_nop 0
  buffer_load_dwordx4 v1, s[12:15], s55 offen lds
  s_add_u32 s55, s55, 65536
  s_add_u32 m0, s57, 17408
  s_nop 0
  buffer_load_dwordx4 v48, s[12:15], s55 offen lds
  s_add_u32 s55, s55, 65536
  s_add_u32 m0, s57, 18432
  s_nop 0
  buffer_load_dwordx4 v1, s[12:15], s55 offen lds
  s_add_u32 s55, s55, 65536
  s_add_u32 m0, s57, 19456
  s_nop 0
  buffer_load_dwordx4 v48, s[12:15], s55 offen lds
  s_waitcnt lgkmcnt(0)
  s_waitcnt vmcnt(12)
  s_barrier
  ds_read_b64_tr_b16 a[172:173], v3 offset:4096
  ds_read_b64_tr_b16 a[174:175], v3 offset:4352
  ds_read_b64_tr_b16 a[180:181], v49 offset:4096
  ds_read_b64_tr_b16 a[182:183], v49 offset:4352
  ds_read_b64_tr_b16 v[140:141], v4 offset:4096
  ds_read_b64_tr_b16 v[142:143], v4 offset:4352
  ds_read_b64_tr_b16 a[204:205], v52 offset:4096
  ds_read_b64_tr_b16 a[206:207], v52 offset:4352
  s_lshl_b32 s55, s41, 2
  s_xor_b32 s55, s55, 9
  s_lshl_b32 s55, s55, 18
  s_add_u32 m0, s57, 20480
  s_nop 0
  buffer_load_dwordx4 v1, s[12:15], s55 offen lds
  s_add_u32 s55, s55, 65536
  s_add_u32 m0, s57, 21504
  s_nop 0
  buffer_load_dwordx4 v48, s[12:15], s55 offen lds
  s_add_u32 s55, s55, 65536
  s_add_u32 m0, s57, 22528
  s_nop 0
  buffer_load_dwordx4 v1, s[12:15], s55 offen lds
  s_add_u32 s55, s55, 65536
  s_add_u32 m0, s57, 23552
  s_nop 0
  buffer_load_dwordx4 v48, s[12:15], s55 offen lds
  s_waitcnt lgkmcnt(0)
  s_waitcnt vmcnt(12)
  s_barrier
  ds_read_b64_tr_b16 a[120:121], v3 offset:8192
  ds_read_b64_tr_b16 a[122:123], v3 offset:8448
  ds_read_b64_tr_b16 a[128:129], v49 offset:8192
  ds_read_b64_tr_b16 a[130:131], v49 offset:8448
  ds_read_b64_tr_b16 v[72:73], v4 offset:8192
  ds_read_b64_tr_b16 v[74:75], v4 offset:8448
  ds_read_b64_tr_b16 a[152:153], v52 offset:8192
  ds_read_b64_tr_b16 a[154:155], v52 offset:8448
  s_lshl_b32 s55, s41, 2
  s_xor_b32 s55, s55, 2
  s_lshl_b32 s55, s55, 18
  s_add_u32 m0, s57, 24576
  s_nop 0
  buffer_load_dwordx4 v1, s[16:19], s55 offen lds
  s_add_u32 s55, s55, 65536
  s_add_u32 m0, s57, 25600
  s_nop 0
  buffer_load_dwordx4 v48, s[16:19], s55 offen lds
  s_add_u32 s55, s55, 65536
  s_add_u32 m0, s57, 26624
  s_nop 0
  buffer_load_dwordx4 v1, s[16:19], s55 offen lds
  s_add_u32 s55, s55, 65536
  s_add_u32 m0, s57, 27648
  s_nop 0
  buffer_load_dwordx4 v48, s[16:19], s55 offen lds
  s_waitcnt lgkmcnt(0)
  s_waitcnt vmcnt(12)
  s_barrier
  ds_read_b64_tr_b16 a[124:125], v3 offset:12288
  ds_read_b64_tr_b16 a[126:127], v3 offset:12544
  ds_read_b64_tr_b16 a[132:133], v49 offset:12288
  ds_read_b64_tr_b16 a[134:135], v49 offset:12544
  ds_read_b64_tr_b16 v[76:77], v4 offset:12288
  ds_read_b64_tr_b16 v[78:79], v4 offset:12544
  ds_read_b64_tr_b16 a[156:157], v52 offset:12288
  ds_read_b64_tr_b16 a[158:159], v52 offset:12544
  s_lshl_b32 s55, s41, 2
  s_xor_b32 s55, s55, 3
  s_lshl_b32 s55, s55, 18
  s_add_u32 m0, s57, 28672
  s_nop 0
  buffer_load_dwordx4 v1, s[16:19], s55 offen lds
  s_add_u32 s55, s55, 65536
  s_add_u32 m0, s57, 29696
  s_nop 0
  buffer_load_dwordx4 v48, s[16:19], s55 offen lds
  s_add_u32 s55, s55, 65536
  s_add_u32 m0, s57, 30720
  s_nop 0
  buffer_load_dwordx4 v1, s[16:19], s55 offen lds
  s_add_u32 s55, s55, 65536
  s_add_u32 m0, s57, 31744
  s_nop 0
  buffer_load_dwordx4 v48, s[16:19], s55 offen lds
  s_waitcnt lgkmcnt(0)
  s_waitcnt vmcnt(12)
  s_barrier
  ds_read_b64_tr_b16 a[32:33], v3 offset:16384
  ds_read_b64_tr_b16 a[34:35], v3 offset:16640
  ds_read_b64_tr_b16 a[40:41], v49 offset:16384
  ds_read_b64_tr_b16 a[42:43], v49 offset:16640
  ds_read_b64_tr_b16 v[80:81], v4 offset:16384
  ds_read_b64_tr_b16 v[82:83], v4 offset:16640
  ds_read_b64_tr_b16 a[64:65], v52 offset:16384
  ds_read_b64_tr_b16 a[66:67], v52 offset:16640
  s_lshl_b32 s55, s41, 2
  s_xor_b32 s55, s55, 0
  s_lshl_b32 s55, s55, 18
  s_add_u32 m0, s57, 32768
  s_nop 0
  buffer_load_dwordx4 v1, s[16:19], s55 offen lds
  s_add_u32 s55, s55, 65536
  s_add_u32 m0, s57, 33792
  s_nop 0
  buffer_load_dwordx4 v48, s[16:19], s55 offen lds
  s_add_u32 s55, s55, 65536
  s_add_u32 m0, s57, 34816
  s_nop 0
  buffer_load_dwordx4 v1, s[16:19], s55 offen lds
  s_add_u32 s55, s55, 65536
  s_add_u32 m0, s57, 35840
  s_nop 0
  buffer_load_dwordx4 v48, s[16:19], s55 offen lds
  s_waitcnt lgkmcnt(0)
  v_cmp_gt_u32 vcc, 256, v58
  s_cbranch_vccnz L_rdy_2
L_rdy_2_ret:
  s_lshl_b32 s62, s40, 2
  s_add_u32 s62, s62, s41
  s_lshl_b32 s62, s62, 7
  s_add_u32 s62, s62, 0x40a4000
  v_lshlrev_b32 v54, 4, v0
  s_mov_b64 exec, 15
  buffer_load_dword v55, v54, s[8:11], s62 offen sc1
  s_mov_b64 exec, -1
  s_waitcnt vmcnt(13)
  s_barrier
  ds_read_b64_tr_b16 a[36:37], v3 offset:20480
  ds_read_b64_tr_b16 a[38:39], v3 offset:20736
  ds_read_b64_tr_b16 a[44:45], v49 offset:20480
  ds_read_b64_tr_b16 a[46:47], v49 offset:20736
  ds_read_b64_tr_b16 v[84:85], v4 offset:20480
  ds_read_b64_tr_b16 v[86:87], v4 offset:20736
  ds_read_b64_tr_b16 a[68:69], v52 offset:20480
  ds_read_b64_tr_b16 a[70:71], v52 offset:20736
  s_lshl_b32 s55, s41, 2
  s_xor_b32 s55, s55, 1
  s_lshl_b32 s55, s55, 18
  s_add_u32 m0, s57, 0
  s_nop 0
  buffer_load_dwordx4 v1, s[16:19], s55 offen lds
  s_add_u32 s55, s55, 65536
  s_add_u32 m0, s57, 1024
  s_nop 0
  buffer_load_dwordx4 v48, s[16:19], s55 offen lds
  s_add_u32 s55, s55, 65536
  s_add_u32 m0, s57, 2048
  s_nop 0
  buffer_load_dwordx4 v1, s[16:19], s55 offen lds
  s_add_u32 s55, s55, 65536
  s_add_u32 m0, s57, 3072
  s_nop 0
  buffer_load_dwordx4 v48, s[16:19], s55 offen lds
  s_waitcnt lgkmcnt(0)
  s_waitcnt vmcnt(13)
  s_barrier
  ds_read_b64_tr_b16 a[88:89], v3 offset:24576
  ds_read_b64_tr_b16 a[90:91], v3 offset:24832
  ds_read_b64_tr_b16 a[96:97], v49 offset:24576
  ds_read_b64_tr_b16 a[98:99], v49 offset:24832
  ds_read_b64_tr_b16 a[112:113], v4 offset:24576
  ds_read_b64_tr_b16 a[114:115], v4 offset:24832
  ds_read_b64_tr_b16 v[8:9], v52 offset:24576
  ds_read_b64_tr_b16 v[10:11], v52 offset:24832
  s_lshl_b32 s55, s41, 2
  s_xor_b32 s55, s55, 2
  s_lshl_b32 s55, s55, 18
  s_add_u32 m0, s57, 4096
  s_nop 0
  buffer_load_dwordx4 v1, s[12:15], s55 offen lds
  s_add_u32 s55, s55, 65536
  s_add_u32 m0, s57, 5120
  s_nop 0
  buffer_load_dwordx4 v48, s[12:15], s55 offen lds
  s_add_u32 s55, s55, 65536
  s_add_u32 m0, s57, 6144
  s_nop 0
  buffer_load_dwordx4 v1, s[12:15], s55 offen lds
  s_add_u32 s55, s55, 65536
  s_add_u32 m0, s57, 7168
  s_nop 0
  buffer_load_dwordx4 v48, s[12:15], s55 offen lds
  ds_write_b128 v6, v[24:27] offset:20480
  ds_write_b128 v6, v[28:31] offset:21504
  ds_write_b128 v6, v[40:43] offset:22528
  ds_write_b128 v6, v[44:47] offset:23552
  s_waitcnt lgkmcnt(0)
  s_waitcnt vmcnt(13)
  s_barrier
  ds_read_b64_tr_b16 a[92:93], v3 offset:28672
  ds_read_b64_tr_b16 a[94:95], v3 offset:28928
  ds_read_b64_tr_b16 a[100:101], v49 offset:28672
  ds_read_b64_tr_b16 a[102:103], v49 offset:28928
  ds_read_b64_tr_b16 a[116:117], v4 offset:28672
  ds_read_b64_tr_b16 a[118:119], v4 offset:28928
  ds_read_b64_tr_b16 v[12:13], v52 offset:28672
  ds_read_b64_tr_b16 v[14:15], v52 offset:28928
  s_lshl_b32 s55, s41, 2
  s_xor_b32 s55, s55, 3
  s_lshl_b32 s55, s55, 18
  s_add_u32 m0, s57, 8192
  s_nop 0
  buffer_load_dwordx4 v1, s[12:15], s55 offen lds
  s_add_u32 s55, s55, 65536
  s_add_u32 m0, s57, 9216
  s_nop 0
  buffer_load_dwordx4 v48, s[12:15], s55 offen lds
  s_add_u32 s55, s55, 65536
  s_add_u32 m0, s57, 10240
  s_nop 0
  buffer_load_dwordx4 v1, s[12:15], s55 offen lds
  s_add_u32 s55, s55, 65536
  s_add_u32 m0, s57, 11264
  s_nop 0
  buffer_load_dwordx4 v48, s[12:15], s55 offen lds
  ds_write_b128 v6, v[88:91] offset:24576
  ds_write_b128 v6, v[92:95] offset:25600
  ds_write_b128 v6, v[96:99] offset:26624
  ds_write_b128 v6, v[100:103] offset:27648
  s_waitcnt lgkmcnt(0)
  s_waitcnt vmcnt(13)
  s_barrier
  ds_read_b64_tr_b16 v[16:17], v3 offset:32768
  ds_read_b64_tr_b16 v[18:19], v3 offset:33024
  ds_read_b64_tr_b16 a[80:81], v49 offset:32768
  ds_read_b64_tr_b16 a[82:83], v49 offset:33024
  ds_read_b64_tr_b16 a[104:105], v4 offset:32768
  ds_read_b64_tr_b16 a[106:107], v4 offset:33024
  ds_read_b64_tr_b16 v[24:25], v52 offset:32768
  ds_read_b64_tr_b16 v[26:27], v52 offset:33024
  s_lshl_b32 s55, s41, 2
  s_xor_b32 s55, s55, 0
  s_lshl_b32 s55, s55, 18
  s_add_u32 m0, s57, 12288
  s_nop 0
  buffer_load_dwordx4 v1, s[12:15], s55 offen lds
  s_add_u32 s55, s55, 65536
  s_add_u32 m0, s57, 13312
  s_nop 0
  buffer_load_dwordx4 v48, s[12:15], s55 offen lds
  s_add_u32 s55, s55, 65536
  s_add_u32 m0, s57, 14336
  s_nop 0
  buffer_load_dwordx4 v1, s[12:15], s55 offen lds
  s_add_u32 s55, s55, 65536
  s_add_u32 m0, s57, 15360
  s_nop 0
  buffer_load_dwordx4 v48, s[12:15], s55 offen lds
  ds_write_b128 v6, v[104:107] offset:28672
  ds_write_b128 v6, v[108:111] offset:29696
  ds_write_b128 v6, v[112:115] offset:30720
  ds_write_b128 v6, v[116:119] offset:31744
  s_waitcnt lgkmcnt(0)
  s_waitcnt vmcnt(12)
  s_barrier
  ds_read_b64_tr_b16 v[20:21], v3 offset:0
  ds_read_b64_tr_b16 v[22:23], v3 offset:256
  ds_read_b64_tr_b16 a[84:85], v49 offset:0
  ds_read_b64_tr_b16 a[86:87], v49 offset:256
  ds_read_b64_tr_b16 a[108:109], v4 offset:0
  ds_read_b64_tr_b16 a[110:111], v4 offset:256
  ds_read_b64_tr_b16 v[28:29], v52 offset:0
  ds_read_b64_tr_b16 v[30:31], v52 offset:256
  s_lshl_b32 s55, s41, 2
  s_xor_b32 s55, s55, 1
  s_lshl_b32 s55, s55, 18
  s_add_u32 m0, s57, 16384
  s_nop 0
  buffer_load_dwordx4 v1, s[12:15], s55 offen lds
  s_add_u32 s55, s55, 65536
  s_add_u32 m0, s57, 17408
  s_nop 0
  buffer_load_dwordx4 v48, s[12:15], s55 offen lds
  s_add_u32 s55, s55, 65536
  s_add_u32 m0, s57, 18432
  s_nop 0
  buffer_load_dwordx4 v1, s[12:15], s55 offen lds
  s_add_u32 s55, s55, 65536
  s_add_u32 m0, s57, 19456
  s_nop 0
  buffer_load_dwordx4 v48, s[12:15], s55 offen lds
  ds_write_b128 v6, v[120:123] offset:32768
  ds_write_b128 v6, v[124:127] offset:33792
  ds_write_b128 v6, v[128:131] offset:34816
  ds_write_b128 v6, v[132:135] offset:35840
  s_waitcnt lgkmcnt(0)
  s_waitcnt vmcnt(12)
  s_barrier
  ds_read_b64_tr_b16 a[8:9], v3 offset:4096
  ds_read_b64_tr_b16 a[10:11], v3 offset:4352
  ds_read_b64_tr_b16 v[40:41], v49 offset:4096
  ds_read_b64_tr_b16 v[42:43], v49 offset:4352
  ds_read_b64_tr_b16 a[24:25], v4 offset:4096
  ds_read_b64_tr_b16 a[26:27], v4 offset:4352
  ds_read_b64_tr_b16 v[88:89], v52 offset:4096
  ds_read_b64_tr_b16 v[90:91], v52 offset:4352
  ds_write_b128 v6, v[136:139] offset:0
  ds_write_b128 v6, v[140:143] offset:1024
  ds_write_b128 v6, v[72:75] offset:2048
  ds_write_b128 v6, v[76:79] offset:3072
  s_waitcnt lgkmcnt(0)
  s_add_u32 s55, s42, 0
  v_cmp_ge_u32 vcc, s55, v55
  s_nop 0
  s_and_b32 s56, vcc_lo, 15
  s_cbranch_scc1 L_kv_3_slow
L_kv_3_ret:
  v_lshlrev_b32 v7, 7, v0
  s_lshl_b32 s55, s41, 13
  s_add_u32 s55, s55, 0x4080000
  buffer_load_dword v56, v7, s[8:11], s55 offen sc1
  s_mul_i32 s55, s40, 10240
  s_add_u32 s55, s55, 0x4000000
  buffer_load_dword v56, v7, s[8:11], s55 offen sc1
  v_lshlrev_b32 v7, 4, v0
  buffer_load_dwordx4 v[56:59], v7, s[8:11], s44 offen offset:0 sc1
  buffer_load_dwordx4 v[60:63], v7, s[8:11], s44 offen offset:1024 sc1
  buffer_load_dwordx4 v[64:67], v7, s[8:11], s44 offen offset:2048 sc1
  buffer_load_dwordx4 v[68:71], v7, s[8:11], s44 offen offset:3072 sc1
  s_waitcnt vmcnt(14)
  s_barrier
  ds_read_b64_tr_b16 a[12:13], v3 offset:8192
  ds_read_b64_tr_b16 a[14:15], v3 offset:8448
  ds_read_b64_tr_b16 v[44:45], v49 offset:8192
  ds_read_b64_tr_b16 v[46:47], v49 offset:8448
  ds_read_b64_tr_b16 a[28:29], v4 offset:8192
  ds_read_b64_tr_b16 a[30:31], v4 offset:8448
  ds_read_b64_tr_b16 v[92:93], v52 offset:8192
  ds_read_b64_tr_b16 v[94:95], v52 offset:8448
  ds_write_b128 v6, v[80:83] offset:4096
  ds_write_b128 v6, v[84:87] offset:5120
  ds_write_b128 v6, v[8:11] offset:6144
  ds_write_b128 v6, v[12:15] offset:7168
  s_waitcnt lgkmcnt(0)
  s_waitcnt vmcnt(10)
  s_barrier
  ds_read_b64_tr_b16 v[96:97], v3 offset:12288
  ds_read_b64_tr_b16 v[98:99], v3 offset:12544
  ds_read_b64_tr_b16 a[0:1], v49 offset:12288
  ds_read_b64_tr_b16 a[2:3], v49 offset:12544
  ds_read_b64_tr_b16 a[16:17], v4 offset:12288
  ds_read_b64_tr_b16 a[18:19], v4 offset:12544
  ds_read_b64_tr_b16 v[104:105], v52 offset:12288
  ds_read_b64_tr_b16 v[106:107], v52 offset:12544
  ds_write_b128 v6, v[16:19] offset:8192
  ds_write_b128 v6, v[20:23] offset:9216
  ds_write_b128 v6, v[24:27] offset:10240
  ds_write_b128 v6, v[28:31] offset:11264
  s_waitcnt lgkmcnt(0)
  s_waitcnt vmcnt(6)
  s_barrier
  ds_read_b64_tr_b16 v[100:101], v3 offset:16384
  ds_read_b64_tr_b16 v[102:103], v3 offset:16640
  ds_read_b64_tr_b16 a[4:5], v49 offset:16384
  ds_read_b64_tr_b16 a[6:7], v49 offset:16640
  ds_read_b64_tr_b16 a[20:21], v4 offset:16384
  ds_read_b64_tr_b16 a[22:23], v4 offset:16640
  ds_read_b64_tr_b16 v[108:109], v52 offset:16384
  ds_read_b64_tr_b16 v[110:111], v52 offset:16640
  ds_write_b128 v6, v[40:43] offset:12288
  ds_write_b128 v6, v[44:47] offset:13312
  ds_write_b128 v6, v[88:91] offset:14336
  ds_write_b128 v6, v[92:95] offset:15360
  s_waitcnt lgkmcnt(0)
  s_barrier
  ds_write_b128 v6, v[96:99] offset:16384
  ds_write_b128 v6, v[100:103] offset:17408
  ds_write_b128 v6, v[104:107] offset:18432
  ds_write_b128 v6, v[108:111] offset:19456
  s_waitcnt lgkmcnt(0)
  v_mov_b32 v116, v6
  v_lshlrev_b32 v105, 4, v0
  v_mov_b32 v119, v55
  s_lshl_b32 s55, s41, 11
  v_add_u32 v106, s55, v105
  v_xor_b32 v107, 0x800, v106
  v_xor_b32 v108, 0x1000, v106
  v_xor_b32 v109, 0x1800, v106
  v_and_b32 v8, 15, v0
  v_lshrrev_b32 v9, 4, v0
  v_and_b32 v10, 7, v0
  v_cmp_gt_u32 vcc, 8, v8
  v_mov_b32 v104, 0xeeee
  v_mov_b32 v11, 0x4444
  v_cndmask_b32 v104, v104, v11, vcc
  v_mov_b32 v11, 0x30000
  v_lshl_add_u32 v113, v9, 3, v10
  v_lshlrev_b32 v113, 4, v113
  s_and_b32 s55, s41, 1
  s_lshl_b32 s55, s55, 9
  s_lshr_b32 s56, s41, 1
  s_lshl_b32 s56, s56, 11
  s_add_u32 s55, s55, s56
  v_add_u32 v112, s55, v113
  v_xor_b32 v100, 0x200, v112
  v_xor_b32 v101, 0x800, v112
  v_xor_b32 v118, 0xa00, v112
  v_cndmask_b32 v112, v11, v112, vcc
  v_and_b32 v111, 0xff, v113
  v_and_b32 v12, 8, v8
  v_add_u32 v111, v12, v111
  v_add_u32 v111, 13312, v111
  s_lshl_b32 s55, s41, 8
  v_add_u32 v110, s55, v111
  v_cmp_gt_u32 vcc, 32, v0
  s_nop 1
  v_cndmask_b32 v110, v11, v110, vcc
  v_lshrrev_b32 v12, 3, v0
  v_mul_u32_u24 v114, 10240, v12
  v_lshl_add_u32 v114, v10, 3, v114
  v_lshlrev_b32 v115, 2, v8
  v_lshl_add_u32 v115, v9, 4, v115
  s_lshr_b32 s55, s40, 3
  s_lshl_b32 s55, s55, 11
  s_bfe_u32 s56, s41, 0x10001
  s_lshl_b32 s56, s56, 10
  s_add_u32 s55, s55, s56
  s_bfe_u32 s56, s41, 0x10000
  s_lshl_b32 s56, s56, 9
  s_add_u32 s55, s55, s56
  s_bfe_u32 s56, s40, 0x10002
  s_lshl_b32 s56, s56, 8
  s_add_u32 s55, s55, s56
  s_bfe_u32 s56, s40, 0x10000
  s_lshl_b32 s56, s56, 7
  s_add_u32 s55, s55, s56
  s_bfe_u32 s56, s40, 0x10001
  s_lshl_b32 s56, s56, 6
  s_add_u32 s55, s55, s56
  v_add_u32 v115, s55, v115
  v_cmp_gt_u32 vcc, 4, v8
  v_bfrev_b32 v12, 1
  s_nop 0
  v_cndmask_b32 v115, v12, v115, vcc
  v_and_b32 v11, 1, v9
  v_lshlrev_b32 v11, 2, v11
  v_sub_u32 v11, v10, v11
  v_mov_b32 v12, 0x3f80
  v_mov_b32 v13, 0x3f800000
  v_mov_b32 v102, 0
  v_cmp_eq_u32 vcc, 0, v11
  s_nop 1
  v_cndmask_b32 v102, v102, v12, vcc
  v_cmp_eq_u32 vcc, 1, v11
  s_nop 1
  v_cndmask_b32 v102, v102, v13, vcc
  v_mov_b32 v103, 0
  v_cmp_eq_u32 vcc, 2, v11
  s_nop 1
  v_cndmask_b32 v103, v103, v12, vcc
  v_cmp_eq_u32 vcc, 3, v11
  s_nop 1
  v_cndmask_b32 v103, v103, v13, vcc
  v_and_b32 v14, 2, v8
  v_cmp_eq_u32 vcc, 0, v14
  v_mov_b32 v15, 0
  s_nop 0
  v_cndmask_b32 v14, v15, v12, vcc
  v_and_b32 v13, 1, v8
  v_cmp_eq_u32 vcc, 0, v13
  s_nop 1
  v_cndmask_b32 v96, v15, v14, vcc
  v_cndmask_b32 v97, v14, v15, vcc
  v_mov_b32 v98, v96
  v_mov_b32 v99, v97
  v_lshrrev_b32 v14, 2, v8
  v_xor_b32 v15, 1, v14
  v_lshl_add_u32 v14, v15, 2, v14
  v_mul_u32_u24 v117, 0x1111, v14
  s_mul_i32 s48, s40, 10240
  s_lshl_b32 s55, s41, 11
  s_add_u32 s48, s48, s55
  s_add_u32 s48, s48, 0x4000000
  s_mov_b32 s49, 0x40c0000
  s_mov_b32 s45, 0x3002000
  s_mov_b32 s43, 0
  v_min_u32 v0, -2, v32
  v_min_u32 v1, -2, v33
  v_min_u32 v2, -2, v34
  v_min_u32 v3, -2, v35
  v_min_u32 v4, -2, v36
  v_min_u32 v5, -2, v37
  v_min_u32 v6, -2, v38
  v_min_u32 v7, -2, v39
  ds_write_b128 v106, v[0:3] offset:0
  ds_write_b128 v106, v[4:7] offset:1024
  s_mov_b32 s55, 0x4086000
  buffer_store_dwordx4 v[4:7], v106, s[8:11], s55 offen offset:1024
  s_waitcnt vmcnt(0)
  s_cmp_eq_u32 s40, 0
  s_cselect_b32 s55, 0x3000000, s49
  buffer_store_dwordx4 v[0:3], v106, s[8:11], s55 offen sc1
  buffer_store_dwordx4 v[4:7], v106, s[8:11], s55 offen offset:1024 sc1
  s_add_u32 s44, s44, 0x4000
  s_mul_i32 s46, s41, 81920
  s_lshl_b32 s55, s40, 6
  s_add_u32 s46, s46, s55
  s_add_u32 s46, s46, 0x4000000
  s_add_u32 s47, s46, 0x1000
  s_lshl_b32 s55, s41, 11
  s_mov_b32 s51, 0x4080000
  s_add_u32 m0, s55, 0
  s_add_u32 s52, s55, 0x4086000
  s_mov_b32 s53, 0x4084000
  s_mov_b32 s58, 0x3e0293ee
  s_mov_b32 s59, 0x3e0293ee
  ds_read_b128 v[120:123], v116 offset:16384
  ds_read_b128 v[124:127], v116 offset:17408
  ds_read_b128 v[128:131], v116 offset:8192
  ds_read_b128 v[132:135], v116 offset:9216
  ds_read_b128 v[136:139], v116 offset:18432
  ds_read_b128 v[140:143], v116 offset:19456
  v_mov_b64 v[32:33], 0
  v_mov_b64 v[34:35], 0
  v_mov_b64 v[36:37], 0
  v_mov_b64 v[38:39], 0
  v_mov_b64 v[40:41], 0
  v_mov_b64 v[42:43], 0
  v_mov_b64 v[44:45], 0
  v_mov_b64 v[46:47], 0
  v_mov_b64 v[48:49], 0
  v_mov_b64 v[50:51], 0
  v_mov_b64 v[52:53], 0
  v_mov_b64 v[54:55], 0
  s_waitcnt lgkmcnt(0)
  s_branch L_chain_body0
.p2align 6
L_retry2:
  s_mov_b64 exec, vcc
  buffer_load_dwordx4 v105, s[8:11], s52 offen sc1 lds
  s_sub_u32 s54, s54, 1
  s_cbranch_scc1 L_fail
  s_waitcnt vmcnt(2)
  ds_read_b128 v[0:3], v106 offset:0
L_ew:
  s_waitcnt lgkmcnt(0)
  v_max3_u32 v95, v0, v1, v2
  v_max_u32 v95, v95, v3
  v_cmp_eq_u32 vcc, -1, v95
  s_cbranch_vccnz L_retry2
  s_mov_b64 exec, -1
L_chain_body:
L_chain_body0:
  buffer_load_dwordx4 v105, s[8:11], s52 offen offset:1024 sc1 lds
  s_barrier
  ds_read_b128 v[8:11], v107 offset:0
  v_smfmac_f32_16x16x64_bf16 v[32:35], v[0:3], v[120:127], v104
  ds_read_b128 v[16:19], v108 offset:0
  v_smfmac_f32_16x16x64_bf16 v[36:39], v[0:3], a[0:7], v104
  ds_read_b128 v[24:27], v109 offset:0
  v_smfmac_f32_16x16x64_bf16 v[40:43], v[0:3], v[128:135], v104
  ds_read_b128 v[120:123], v116 offset:4096
  v_smfmac_f32_16x16x64_bf16 v[44:47], v[0:3], a[80:87], v104
  ds_read_b128 v[124:127], v116 offset:5120
  s_waitcnt lgkmcnt(4)
  v_smfmac_f32_16x16x64_bf16 v[32:35], v[8:11], a[16:23], v104
  ds_read_b128 v[128:131], v116 offset:10240
  v_smfmac_f32_16x16x64_bf16 v[36:39], v[8:11], v[136:143], v104
  ds_read_b128 v[132:135], v116 offset:11264
  s_waitcnt lgkmcnt(5)
  v_smfmac_f32_16x16x64_bf16 v[32:35], v[16:19], a[32:39], v104
  ds_read_b128 v[136:139], v116 offset:2048
  v_smfmac_f32_16x16x64_bf16 v[36:39], v[16:19], a[40:47], v104
  ds_read_b128 v[140:143], v116 offset:3072
  s_waitcnt lgkmcnt(6)
  s_waitcnt lgkmcnt(4)
  v_smfmac_f32_16x16x64_bf16 v[32:35], v[24:27], v[120:127], v104
  ds_read_b128 v[120:123], v116 offset:12288
  v_smfmac_f32_16x16x64_bf16 v[36:39], v[24:27], a[64:71], v104
  ds_read_b128 v[124:127], v116 offset:13312
  s_waitcnt vmcnt(1)
  ds_read_b128 v[4:7], v106 offset:1024
  v_smfmac_f32_16x16x64_bf16 v[40:43], v[8:11], a[104:111], v104
  s_waitcnt lgkmcnt(5)
  v_smfmac_f32_16x16x64_bf16 v[44:47], v[8:11], v[128:135], v104
  ds_read_b128 v[128:131], v116 offset:14336
  v_smfmac_f32_16x16x64_bf16 v[40:43], v[16:19], a[120:127], v104
  ds_read_b128 v[132:135], v116 offset:15360
  v_smfmac_f32_16x16x64_bf16 v[44:47], v[16:19], a[128:135], v104
  s_waitcnt lgkmcnt(2)
  v_max3_u32 v95, v4, v5, v6
  v_smfmac_f32_16x16x64_bf16 v[40:43], v[24:27], v[136:143], v104
  ds_read_b128 v[136:139], v116 offset:34816
  v_max_u32 v95, v95, v7
  v_cmp_eq_u32 vcc, -1, v95
  v_smfmac_f32_16x16x64_bf16 v[44:47], v[24:27], a[152:159], v104
  s_cbranch_vccnz L_retry3
L_ret3:
  s_barrier
  ds_read_b128 v[12:15], v107 offset:1024
  v_smfmac_f32_16x16x64_bf16 v[32:35], v[4:7], a[8:15], v104
  ds_read_b128 v[20:23], v108 offset:1024
  s_add_u32 s55, s42, 1
  s_cmp_eq_u32 s55, 22
  s_cselect_b32 s55, 63, s55
  v_cmp_ge_u32 vcc, s55, v119
  v_smfmac_f32_16x16x64_bf16 v[36:39], v[4:7], v[120:127], v104
  ds_read_b128 v[28:31], v109 offset:1024
  s_and_b32 s56, vcc_lo, 15
  s_cbranch_scc1 L_kv_5_slow
L_kv_5_ret:
  v_smfmac_f32_16x16x64_bf16 v[40:43], v[4:7], a[88:95], v104
  buffer_load_dwordx4 v[72:75], v105, s[8:11], s44 offen offset:0 sc1
  v_smfmac_f32_16x16x64_bf16 v[44:47], v[4:7], a[96:103], v104
  ds_read_b128 v[140:143], v116 offset:35840
  s_waitcnt lgkmcnt(3)
  v_smfmac_f32_16x16x64_bf16 v[32:35], v[12:15], a[24:31], v104
  ds_read_b128 v[120:123], v116 offset:6144
  v_smfmac_f32_16x16x64_bf16 v[36:39], v[12:15], v[128:135], v104
  ds_read_b128 v[124:127], v116 offset:7168
  s_waitcnt lgkmcnt(4)
  v_smfmac_f32_16x16x64_bf16 v[32:35], v[20:23], a[48:55], v104
  buffer_load_dwordx4 v[76:79], v105, s[8:11], s44 offen offset:1024 sc1
  v_smfmac_f32_16x16x64_bf16 v[36:39], v[20:23], a[56:63], v104
  ds_read_b128 v[128:131], v116 offset:32768
  s_waitcnt lgkmcnt(4)
  s_waitcnt lgkmcnt(3)
  v_smfmac_f32_16x16x64_bf16 v[32:35], v[28:31], v[136:143], v104
  ds_read_b128 v[132:135], v116 offset:33792
  v_smfmac_f32_16x16x64_bf16 v[36:39], v[28:31], a[72:79], v104
  ds_read_b128 v[136:139], v116 offset:0
  v_smfmac_f32_16x16x64_bf16 v[40:43], v[12:15], a[112:119], v104
  buffer_load_dwordx4 v[80:83], v105, s[8:11], s44 offen offset:2048 sc1
  s_waitcnt lgkmcnt(3)
  v_smfmac_f32_16x16x64_bf16 v[44:47], v[12:15], v[120:127], v104
  ds_read_b128 v[140:143], v116 offset:1024
  v_cvt_pk_bf16_f32 v88, v32, v33
  v_smfmac_f32_16x16x64_bf16 v[40:43], v[20:23], a[136:143], v104
  ds_read_b128 v[120:123], v116 offset:28672
  v_cvt_pk_bf16_f32 v89, v34, v35
  v_smfmac_f32_16x16x64_bf16 v[44:47], v[20:23], a[144:151], v104
  ds_read_b128 v[124:127], v116 offset:29696
  v_cvt_pk_bf16_f32 v90, v36, v37
  s_waitcnt lgkmcnt(4)
  v_smfmac_f32_16x16x64_bf16 v[40:43], v[28:31], v[128:135], v104
  buffer_load_dwordx4 v[84:87], v105, s[8:11], s44 offen offset:3072 sc1
  v_cvt_pk_bf16_f32 v91, v38, v39
  v_smfmac_f32_16x16x64_bf16 v[44:47], v[28:31], a[160:167], v104
  ds_read_b128 v[128:131], v116 offset:30720
  v_mfma_f32_16x16x16_bf16 v[32:35], v[88:89], v[102:103], 0
  ds_read_b128 v[132:135], v116 offset:31744
  s_add_u32 s44, s44, 0x4000
  v_mfma_f32_16x16x16_bf16 v[36:39], v[90:91], v[102:103], 0
  buffer_store_dword v113, v115, s[8:11], s49 offen sc1
  v_cvt_pk_bf16_f32 v92, v40, v41
  v_cvt_pk_bf16_f32 v93, v42, v43
  s_waitcnt lgkmcnt(4)
  v_smfmac_f32_16x16x64_bf16 v[48:51], v[8:11], v[136:143], v104
  ds_read_b128 v[136:139], v116 offset:20480
  v_cvt_pk_bf16_f32 v94, v44, v45
  v_cvt_pk_bf16_f32 v95, v46, v47
  v_mfma_f32_16x16x16_bf16 v[40:43], v[92:93], v[102:103], 0
  ds_read_b128 v[140:143], v116 offset:21504
  v_cvt_pk_bf16_f32 v88, v32, v33
  v_cvt_pk_bf16_f32 v89, v34, v35
  v_mfma_f32_16x16x16_bf16 v[44:47], v[94:95], v[102:103], 0
  s_mov_b64 exec, 15
  buffer_load_dword v119, v105, s[8:11], s62 offen sc1
  s_mov_b64 exec, -1
  v_cvt_pk_bf16_f32 v90, v36, v37
  v_cvt_pk_bf16_f32 v91, v38, v39
  v_smfmac_f32_16x16x64_bf16 v[48:51], v[4:7], a[184:191], v104
  v_mfma_f32_16x16x32_bf16 v[32:35], v[56:59], v[88:91], 0
  v_cvt_pk_bf16_f32 v92, v40, v41
  v_cvt_pk_bf16_f32 v93, v42, v43
  v_mfma_f32_16x16x32_bf16 v[36:39], v[60:63], v[88:91], 0
  v_cvt_pk_bf16_f32 v94, v44, v45
  v_cvt_pk_bf16_f32 v95, v46, v47
  s_waitcnt lgkmcnt(4)
  v_smfmac_f32_16x16x64_bf16 v[48:51], v[12:15], v[120:127], v104
  ds_read_b128 v[120:123], v116 offset:24576
  v_mfma_f32_16x16x32_bf16 v[40:43], v[92:95], v[88:91], 0
  ds_read_b128 v[124:127], v116 offset:25600
  v_mov_b32_dpp v32, v36 quad_perm:[0,1,2,3] row_mask:0xf bank_mask:0xc
  v_mov_b32_dpp v33, v37 quad_perm:[0,1,2,3] row_mask:0xf bank_mask:0xc
  v_mov_b32_dpp v34, v38 quad_perm:[0,1,2,3] row_mask:0xf bank_mask:0xc
  v_mov_b32_dpp v35, v39 quad_perm:[0,1,2,3] row_mask:0xf bank_mask:0xc
  v_smfmac_f32_16x16x64_bf16 v[52:55], v[4:7], a[192:199], v104
  ds_write_b128 v106, v[32:35] offset:8192
  s_nop 0
  v_mov_b32_dpp v40, v42 quad_perm:[0,1,2,3] row_mask:0xf bank_mask:0xc
  v_mov_b32_dpp v41, v43 quad_perm:[0,1,2,3] row_mask:0xf bank_mask:0xc
  v_smfmac_f32_16x16x64_bf16 v[52:55], v[12:15], a[208:215], v104
  ds_write_b64 v110, v[40:41]
  s_waitcnt lgkmcnt(6)
  v_smfmac_f32_16x16x64_bf16 v[48:51], v[16:19], v[128:135], v104
  ds_read_b128 v[128:131], v116 offset:22528
  v_smfmac_f32_16x16x64_bf16 v[48:51], v[0:3], a[168:175], v104
  ds_read_b128 v[132:135], v116 offset:23552
  v_smfmac_f32_16x16x64_bf16 v[52:55], v[0:3], a[176:183], v104
  v_smfmac_f32_16x16x64_bf16 v[48:51], v[20:23], a[224:231], v104
  v_smfmac_f32_16x16x64_bf16 v[52:55], v[20:23], a[232:239], v104
  s_waitcnt lgkmcnt(2)
  s_barrier
  ds_read_b128 v[56:59], v107 offset:8192
  v_smfmac_f32_16x16x64_bf16 v[48:51], v[28:31], v[144:151], v104
  ds_read_b128 v[60:63], v108 offset:8192
  v_smfmac_f32_16x16x64_bf16 v[52:55], v[28:31], v[152:159], v104
  ds_read_b128 v[36:39], v109 offset:8192
  v_smfmac_f32_16x16x64_bf16 v[52:55], v[8:11], a[200:207], v104
  ds_read2_b64 v[40:43], v111 offset0:0 offset1:32
  v_smfmac_f32_16x16x64_bf16 v[52:55], v[16:19], a[216:223], v104
  ds_read2_b64 v[44:47], v111 offset0:64 offset1:96
  v_smfmac_f32_16x16x64_bf16 v[48:51], v[24:27], a[240:247], v104
  v_smfmac_f32_16x16x64_bf16 v[52:55], v[24:27], a[248:255], v104
  s_waitcnt lgkmcnt(4)
  v_pk_add_f32 v[56:57], v[56:57], v[32:33]
  v_pk_add_f32 v[58:59], v[58:59], v[34:35]
  s_waitcnt lgkmcnt(2)
  v_pk_add_f32 v[36:37], v[36:37], v[60:61]
  v_pk_add_f32 v[38:39], v[38:39], v[62:63]
  v_pk_add_f32 v[56:57], v[56:57], v[36:37]
  v_pk_add_f32 v[58:59], v[58:59], v[38:39]
  s_waitcnt lgkmcnt(0)
  v_pk_add_f32 v[40:41], v[40:41], v[42:43]
  v_pk_add_f32 v[44:45], v[44:45], v[46:47]
  v_max3_f32 v0, v56, v57, v58
  v_pk_add_f32 v[40:41], v[40:41], v[44:45]
  v_max_f32 v0, v0, v59
  v_max3_f32 v0, v0, v40, v41
  v_cvt_pk_bf16_f32 v60, v48, v49
  v_cvt_pk_bf16_f32 v61, v50, v51
  v_max_f32_dpp v0, v0, v0 row_ror:8 row_mask:0xf bank_mask:0xf
  v_mov_b32 v1, v0
  v_cvt_pk_bf16_f32 v62, v52, v53
  v_cvt_pk_bf16_f32 v63, v54, v55
  v_permlane16_swap_b32 v0, v1
  v_max_f32 v0, v0, v1
  v_mov_b32 v1, v0
  v_mov_b64 v[16:17], 0
  v_mov_b64 v[18:19], 0
  v_permlane32_swap_b32 v0, v1
  v_max_f32 v0, v0, v1
  v_mul_f32 v0, s58, v0
  v_pk_fma_f32 v[56:57], v[56:57], s[58:59], v[0:1] op_sel_hi:[1,1,0] neg_lo:[0,0,1] neg_hi:[0,0,1]
  v_pk_fma_f32 v[58:59], v[58:59], s[58:59], v[0:1] op_sel_hi:[1,1,0] neg_lo:[0,0,1] neg_hi:[0,0,1]
  v_pk_fma_f32 v[40:41], v[40:41], s[58:59], v[0:1] op_sel_hi:[1,1,0] neg_lo:[0,0,1] neg_hi:[0,0,1]
  v_exp_f32 v56, v56
  v_exp_f32 v57, v57
  v_exp_f32 v58, v58
  v_exp_f32 v59, v59
  v_exp_f32 v40, v40
  v_cvt_pk_bf16_f32 v88, v56, v57
  v_cvt_pk_bf16_f32 v89, v58, v59
  v_exp_f32 v41, v41
  v_mov_b32_dpp v90, v88 row_ror:8 row_mask:0xf bank_mask:0xf
  v_mov_b32_dpp v91, v89 row_ror:8 row_mask:0xf bank_mask:0xf
  v_cvt_pk_bf16_f32 v2, v40, v41
  v_pk_add_f32 v[56:57], v[56:57], v[58:59]
  v_mfma_f32_16x16x32_bf16 v[32:35], v[64:67], v[88:91], 0
  v_mov_b32_dpp v3, v2 row_ror:8 row_mask:0xf bank_mask:0xf
  v_add_f32 v40, v40, v41
  v_mfma_f32_16x16x32_bf16 v[36:39], v[68:71], v[88:91], 0
  v_add_f32 v56, v56, v57
  v_fma_f32 v0, v40, 0.5, v56
  v_mfma_f32_16x16x16_bf16 v[32:35], v[60:61], v[2:3], v[32:35]
  s_nop 0
  v_add_f32_dpp v0, v0, v0 row_ror:8 row_mask:0xf bank_mask:0xf
  v_mov_b32 v1, v0
  v_mfma_f32_16x16x16_bf16 v[36:39], v[62:63], v[2:3], v[36:39]
  s_nop 0
  v_permlane16_swap_b32 v0, v1
  v_add_f32 v0, v0, v1
  v_mov_b32 v1, v0
  v_mov_b64 v[20:21], 0
  v_mov_b64 v[22:23], 0
  v_permlane32_swap_b32 v0, v1
  v_add_f32 v0, v0, v1
  v_rcp_f32 v0, v0
  v_mov_b64 v[24:25], 0
  v_pk_mul_f32 v[32:33], v[32:33], v[0:1] op_sel_hi:[1,0]
  v_pk_mul_f32 v[34:35], v[34:35], v[0:1] op_sel_hi:[1,0]
  v_pk_mul_f32 v[36:37], v[36:37], v[0:1] op_sel_hi:[1,0]
  v_pk_mul_f32 v[38:39], v[38:39], v[0:1] op_sel_hi:[1,0]
  v_cvt_pk_bf16_f32 v88, v32, v33
  v_cvt_pk_bf16_f32 v89, v34, v35
  v_cvt_pk_bf16_f32 v90, v36, v37
  v_cvt_pk_bf16_f32 v91, v38, v39
  ds_write_b128 v112, v[88:91] offset:9216
  v_mov_b32_dpp v88, v88 row_ror:8 row_mask:0xf bank_mask:0xc
  v_mov_b32_dpp v89, v89 row_ror:8 row_mask:0xf bank_mask:0xc
  v_mov_b32_dpp v90, v90 row_ror:8 row_mask:0xf bank_mask:0xc
  v_mov_b32_dpp v91, v91 row_ror:8 row_mask:0xf bank_mask:0xc
  v_mov_b64 v[26:27], 0
  v_mov_b64 v[28:29], 0
  v_mov_b64 v[30:31], 0
  v_mov_b64 v[48:49], 0
  v_mov_b64 v[50:51], 0
  v_mov_b64 v[52:53], 0
  v_mov_b64 v[54:55], 0
  s_mov_b32 s49, s45
  s_add_u32 s45, s45, 0x2000
  v_smfmac_f32_16x16x64_bf16 v[16:19], v[88:91], v[160:167], v104
  s_waitcnt lgkmcnt(0)
  s_barrier
  ds_read_b128 v[4:7], v100 offset:9216
  v_smfmac_f32_16x16x64_bf16 v[20:23], v[88:91], v[192:199], v104
  ds_read_b128 v[8:11], v101 offset:9216
  v_smfmac_f32_16x16x64_bf16 v[24:27], v[88:91], v[136:143], v104
  ds_read_b128 v[12:15], v118 offset:9216
  v_smfmac_f32_16x16x64_bf16 v[28:31], v[88:91], v[232:239], v104
  ds_read_b128 v[136:139], v116 offset:26624
  s_waitcnt lgkmcnt(3)
  v_smfmac_f32_16x16x64_bf16 v[16:19], v[4:7], v[168:175], v104
  ds_read_b128 v[140:143], v116 offset:27648
  v_mov_b64 v[40:41], 0
  s_waitcnt lgkmcnt(3)
  v_smfmac_f32_16x16x64_bf16 v[16:19], v[8:11], v[176:183], v104
  v_mov_b64 v[42:43], 0
  s_waitcnt lgkmcnt(2)
  v_smfmac_f32_16x16x64_bf16 v[16:19], v[12:15], v[184:191], v104
  v_mov_b64 v[44:45], 0
  v_smfmac_f32_16x16x64_bf16 v[20:23], v[4:7], v[200:207], v104
  v_mov_b64 v[46:47], 0
  v_smfmac_f32_16x16x64_bf16 v[20:23], v[8:11], v[120:127], v104
  ds_read_b128 v[120:123], v116 offset:16384
  v_cvt_pk_bf16_f32 v32, v16, v17
  v_cvt_pk_bf16_f32 v33, v18, v19
  v_bfi_b32 v32, 1, s43, v32
  v_smfmac_f32_16x16x64_bf16 v[20:23], v[12:15], v[208:215], v104
  buffer_store_dwordx2 v[32:33], v114, s[8:11], s46 offen offset:0
  v_smfmac_f32_16x16x64_bf16 v[24:27], v[4:7], v[128:135], v104
  ds_read_b128 v[124:127], v116 offset:17408
  v_mov_b64 v[16:17], 0
  v_smfmac_f32_16x16x64_bf16 v[24:27], v[8:11], v[216:223], v104
  ds_read_b128 v[128:131], v116 offset:8192
  v_cvt_pk_bf16_f32 v34, v20, v21
  v_cvt_pk_bf16_f32 v35, v22, v23
  v_bfi_b32 v34, 1, s43, v34
  v_smfmac_f32_16x16x64_bf16 v[24:27], v[12:15], v[224:231], v104
  buffer_store_dwordx2 v[34:35], v114, s[8:11], s46 offen offset:2048
  v_smfmac_f32_16x16x64_bf16 v[28:31], v[4:7], v[240:247], v104
  ds_read_b128 v[132:135], v116 offset:9216
  v_mov_b64 v[18:19], 0
  v_smfmac_f32_16x16x64_bf16 v[28:31], v[8:11], v[248:255], v104
  s_nop 0
  v_cvt_pk_bf16_f32 v36, v24, v25
  v_cvt_pk_bf16_f32 v37, v26, v27
  v_bfi_b32 v36, 1, s43, v36
  s_waitcnt lgkmcnt(4)
  v_smfmac_f32_16x16x64_bf16 v[28:31], v[12:15], v[136:143], v104
  buffer_store_dwordx2 v[36:37], v114, s[8:11], s47 offen offset:0
  ds_read_b128 v[136:139], v116 offset:18432
  ds_read_b128 v[140:143], v116 offset:19456
  s_mov_b32 s54, 1048576
  s_add_u32 s52, s52, 0x2000
  s_and_b32 s52, s52, 0xffff7fff
  s_add_u32 s42, s42, 1
  v_mov_b64 v[32:33], 0
  v_mov_b64 v[34:35], 0
  v_cvt_pk_bf16_f32 v38, v28, v29
  v_cvt_pk_bf16_f32 v39, v30, v31
  v_bfi_b32 v38, 1, s43, v38
  buffer_store_dwordx2 v[38:39], v114, s[8:11], s47 offen offset:2048
  s_cmp_lt_u32 s41, 2
  s_cbranch_scc1 L_early
  s_nop 15
  s_nop 15
  s_nop 13
L_early:
  v_mov_b64 v[36:37], 0
  v_mov_b64 v[38:39], 0
  s_nop 15
  s_nop 9
  buffer_load_dwordx4 v[8:11], v105, s[8:11], s48 offen sc1
  buffer_load_dwordx4 v[12:15], v105, s[8:11], s48 offen offset:1024 sc1
  s_nop 15
  s_nop 3
  buffer_load_dwordx4 v[20:23], v105, s[8:11], s48 offen sc1
  buffer_load_dwordx4 v[24:27], v105, s[8:11], s48 offen offset:1024 sc1
  s_cmp_eq_u32 s42, 63
L_h1w:
  s_waitcnt vmcnt(2)
  v_smfmac_f32_16x16x64_bf16 v[16:19], v[96:99], v[8:15], v117
  v_bitop3_b32 v95, v8, v10, s43 bitop3:0x7e
  v_bitop3_b32 v94, v12, v14, s43 bitop3:0x7e
  v_bitop3_b32 v95, v95, v94, 1 bitop3:0xa8
  v_cmp_ne_u32 vcc, 0, v95
  v_mov_b32 v95, -1
  s_cbranch_vccnz L_h1r0
L_h1ok:
  v_mov_b64 v[56:57], v[72:73]
  s_nop 0
  v_add_f32_dpp v16, v16, v16 row_ror:4 row_mask:0xf bank_mask:0xf
  v_add_f32_dpp v17, v17, v17 row_ror:4 row_mask:0xf bank_mask:0xf
  s_nop 0
  v_add_f32_dpp v16, v16, v16 row_ror:8 row_mask:0xf bank_mask:0xf
  v_add_f32_dpp v17, v17, v17 row_ror:8 row_mask:0xf bank_mask:0xf
  v_cvt_pk_bf16_f32 v113, v16, v17
  v_min_u32 v113, -2, v113
  s_cbranch_scc1 L_chain_done
  buffer_store_dword v113, v115, s[8:11], s51 offen
  buffer_store_dword v95, v115, s[8:11], s53 offen
  s_cmp_lt_u32 s41, 2
  s_cbranch_scc1 L_early2
L_late2:
  buffer_load_dwordx4 v105, s[8:11], s52 offen sc1 lds
  v_mov_b64 v[58:59], v[74:75]
  v_mov_b64 v[60:61], v[76:77]
  v_mov_b64 v[62:63], v[78:79]
  v_mov_b64 v[64:65], v[80:81]
  v_mov_b64 v[66:67], v[82:83]
  v_mov_b64 v[68:69], v[84:85]
  v_mov_b64 v[70:71], v[86:87]
  s_xor_b32 s43, s43, 1
  s_add_u32 s51, s51, 0x2000
  s_and_b32 s51, s51, 0xffff7fff
  s_add_u32 s53, s53, 0x2000
  s_and_b32 s53, s53, 0xffff7fff
  s_mov_b32 s54, 1048576
  s_waitcnt lgkmcnt(0)
  s_nop 15
  s_nop 7
  buffer_load_dwordx4 v105, s[8:11], s52 offen sc1 lds
  s_nop 13
  buffer_load_dwordx4 v105, s[8:11], s52 offen offset:1024 sc1 lds
  s_waitcnt vmcnt(2)
  ds_read_b128 v[0:3], v106 offset:0
  s_cmp_eq_u32 s42, 22
  s_cbranch_scc1 L_ew_b
  s_branch L_ew
L_h1r0:
  s_mov_b64 exec, vcc
  buffer_load_dwordx4 v[8:11], v105, s[8:11], s48 offen sc1
  buffer_load_dwordx4 v[12:15], v105, s[8:11], s48 offen offset:1024 sc1
  s_mov_b64 exec, -1
  s_sub_u32 s54, s54, 1
  s_cbranch_scc1 L_fail
  s_cmp_eq_u32 s42, 63
  v_mov_b64 v[16:17], 0
  v_mov_b64 v[18:19], 0
  s_waitcnt vmcnt(2)
  s_nop 0
  v_smfmac_f32_16x16x64_bf16 v[16:19], v[96:99], v[20:27], v117
  v_bitop3_b32 v95, v20, v22, s43 bitop3:0x7e
  v_bitop3_b32 v94, v24, v26, s43 bitop3:0x7e
  v_bitop3_b32 v95, v95, v94, 1 bitop3:0xa8
  v_cmp_ne_u32 vcc, 0, v95
  v_mov_b32 v95, -1
  s_cbranch_vccz L_h1ok
L_h1r1:
  s_mov_b64 exec, vcc
  buffer_load_dwordx4 v[20:23], v105, s[8:11], s48 offen sc1
  buffer_load_dwordx4 v[24:27], v105, s[8:11], s48 offen offset:1024 sc1
  s_mov_b64 exec, -1
  s_sub_u32 s54, s54, 1
  s_cbranch_scc1 L_fail
  s_cmp_eq_u32 s42, 63
  v_mov_b64 v[16:17], 0
  v_mov_b64 v[18:19], 0
  s_branch L_h1w
L_early2:
  s_nop 15
  s_nop 15
  s_nop 1
  s_branch L_late2
L_retry3:
  s_mov_b64 exec, vcc
  buffer_load_dwordx4 v105, s[8:11], s52 offen offset:1024 sc1 lds
  s_sub_u32 s54, s54, 1
  s_cbranch_scc1 L_fail
  s_waitcnt vmcnt(1)
  ds_read_b128 v[4:7], v106 offset:1024
  s_waitcnt lgkmcnt(0)
  v_max3_u32 v95, v4, v5, v6
  v_max_u32 v95, v95, v7
  v_cmp_eq_u32 vcc, -1, v95
  s_cbranch_vccnz L_retry3
  s_mov_b64 exec, -1
  s_branch L_ret3
.p2align 6
L_retry2_b:
  s_mov_b64 exec, vcc
  buffer_load_dwordx4 v105, s[8:11], s52 offen sc1 lds
  s_sub_u32 s54, s54, 1
  s_cbranch_scc1 L_fail
  s_waitcnt vmcnt(2)
  ds_read_b128 v[0:3], v106 offset:0
L_ew_b:
  s_waitcnt lgkmcnt(0)
  v_max3_u32 v95, v0, v1, v2
  v_max_u32 v95, v95, v3
  v_cmp_eq_u32 vcc, -1, v95
  s_cbranch_vccnz L_retry2_b
  s_mov_b64 exec, -1
L_chain_body_b:
L_chain_body0_b:
  buffer_load_dwordx4 v105, s[8:11], s52 offen offset:1024 sc1 lds
  s_barrier
  ds_read_b128 v[8:11], v107 offset:0
  v_smfmac_f32_16x16x64_bf16 v[32:35], v[0:3], v[120:127], v104
  ds_read_b128 v[16:19], v108 offset:0
  v_smfmac_f32_16x16x64_bf16 v[36:39], v[0:3], a[0:7], v104
  ds_read_b128 v[24:27], v109 offset:0
  v_smfmac_f32_16x16x64_bf16 v[40:43], v[0:3], v[128:135], v104
  ds_read_b128 v[120:123], v116 offset:4096
  v_smfmac_f32_16x16x64_bf16 v[44:47], v[0:3], a[80:87], v104
  ds_read_b128 v[124:127], v116 offset:5120
  s_waitcnt lgkmcnt(4)
  v_smfmac_f32_16x16x64_bf16 v[32:35], v[8:11], a[16:23], v104
  ds_read_b128 v[128:131], v116 offset:10240
  v_smfmac_f32_16x16x64_bf16 v[36:39], v[8:11], v[136:143], v104
  ds_read_b128 v[132:135], v116 offset:11264
  s_waitcnt lgkmcnt(5)
  v_smfmac_f32_16x16x64_bf16 v[32:35], v[16:19], a[32:39], v104
  ds_read_b128 v[136:139], v116 offset:2048
  v_smfmac_f32_16x16x64_bf16 v[36:39], v[16:19], a[40:47], v104
  ds_read_b128 v[140:143], v116 offset:3072
  s_waitcnt lgkmcnt(6)
  s_waitcnt lgkmcnt(4)
  v_smfmac_f32_16x16x64_bf16 v[32:35], v[24:27], v[120:127], v104
  ds_read_b128 v[120:123], v116 offset:12288
  v_smfmac_f32_16x16x64_bf16 v[36:39], v[24:27], a[64:71], v104
  ds_read_b128 v[124:127], v116 offset:13312
  s_waitcnt vmcnt(1)
  ds_read_b128 v[4:7], v106 offset:1024
  v_smfmac_f32_16x16x64_bf16 v[40:43], v[8:11], a[104:111], v104
  s_waitcnt lgkmcnt(5)
  v_smfmac_f32_16x16x64_bf16 v[44:47], v[8:11], v[128:135], v104
  ds_read_b128 v[128:131], v116 offset:14336
  v_smfmac_f32_16x16x64_bf16 v[40:43], v[16:19], a[120:127], v104
  ds_read_b128 v[132:135], v116 offset:15360
  v_smfmac_f32_16x16x64_bf16 v[44:47], v[16:19], a[128:135], v104
  s_waitcnt lgkmcnt(2)
  v_max3_u32 v95, v4, v5, v6
  v_smfmac_f32_16x16x64_bf16 v[40:43], v[24:27], v[136:143], v104
  ds_read_b128 v[136:139], v116 offset:34816
  v_max_u32 v95, v95, v7
  v_cmp_eq_u32 vcc, -1, v95
  v_smfmac_f32_16x16x64_bf16 v[44:47], v[24:27], a[152:159], v104
  s_cbranch_vccnz L_retry3_b
L_ret3_b:
  s_barrier
  ds_read_b128 v[12:15], v107 offset:1024
  v_smfmac_f32_16x16x64_bf16 v[32:35], v[4:7], a[8:15], v104
  ds_read_b128 v[20:23], v108 offset:1024
  v_smfmac_f32_16x16x64_bf16 v[36:39], v[4:7], v[120:127], v104
  ds_read_b128 v[28:31], v109 offset:1024
  v_smfmac_f32_16x16x64_bf16 v[40:43], v[4:7], a[88:95], v104
  buffer_load_dwordx4 v[72:75], v105, s[8:11], s44 offen offset:0 sc1
  v_smfmac_f32_16x16x64_bf16 v[44:47], v[4:7], a[96:103], v104
  ds_read_b128 v[140:143], v116 offset:35840
  s_waitcnt lgkmcnt(3)
  v_smfmac_f32_16x16x64_bf16 v[32:35], v[12:15], a[24:31], v104
  ds_read_b128 v[120:123], v116 offset:6144
  v_smfmac_f32_16x16x64_bf16 v[36:39], v[12:15], v[128:135], v104
  ds_read_b128 v[124:127], v116 offset:7168
  s_waitcnt lgkmcnt(4)
  v_smfmac_f32_16x16x64_bf16 v[32:35], v[20:23], a[48:55], v104
  buffer_load_dwordx4 v[76:79], v105, s[8:11], s44 offen offset:1024 sc1
  v_smfmac_f32_16x16x64_bf16 v[36:39], v[20:23], a[56:63], v104
  ds_read_b128 v[128:131], v116 offset:32768
  s_waitcnt lgkmcnt(4)
  s_waitcnt lgkmcnt(3)
  v_smfmac_f32_16x16x64_bf16 v[32:35], v[28:31], v[136:143], v104
  ds_read_b128 v[132:135], v116 offset:33792
  v_smfmac_f32_16x16x64_bf16 v[36:39], v[28:31], a[72:79], v104
  ds_read_b128 v[136:139], v116 offset:0
  v_smfmac_f32_16x16x64_bf16 v[40:43], v[12:15], a[112:119], v104
  buffer_load_dwordx4 v[80:83], v105, s[8:11], s44 offen offset:2048 sc1
  s_waitcnt lgkmcnt(3)
  v_smfmac_f32_16x16x64_bf16 v[44:47], v[12:15], v[120:127], v104
  ds_read_b128 v[140:143], v116 offset:1024
  v_cvt_pk_bf16_f32 v88, v32, v33
  v_smfmac_f32_16x16x64_bf16 v[40:43], v[20:23], a[136:143], v104
  ds_read_b128 v[120:123], v116 offset:28672
  v_cvt_pk_bf16_f32 v89, v34, v35
  v_smfmac_f32_16x16x64_bf16 v[44:47], v[20:23], a[144:151], v104
  ds_read_b128 v[124:127], v116 offset:29696
  v_cvt_pk_bf16_f32 v90, v36, v37
  s_waitcnt lgkmcnt(4)
  v_smfmac_f32_16x16x64_bf16 v[40:43], v[28:31], v[128:135], v104
  buffer_load_dwordx4 v[84:87], v105, s[8:11], s44 offen offset:3072 sc1
  v_cvt_pk_bf16_f32 v91, v38, v39
  v_smfmac_f32_16x16x64_bf16 v[44:47], v[28:31], a[160:167], v104
  ds_read_b128 v[128:131], v116 offset:30720
  v_mfma_f32_16x16x16_bf16 v[32:35], v[88:89], v[102:103], 0
  ds_read_b128 v[132:135], v116 offset:31744
  s_add_u32 s44, s44, 0x4000
  v_mfma_f32_16x16x16_bf16 v[36:39], v[90:91], v[102:103], 0
  buffer_store_dword v113, v115, s[8:11], s49 offen sc1
  v_cvt_pk_bf16_f32 v92, v40, v41
  v_cvt_pk_bf16_f32 v93, v42, v43
  s_waitcnt lgkmcnt(4)
  v_smfmac_f32_16x16x64_bf16 v[48:51], v[8:11], v[136:143], v104
  ds_read_b128 v[136:139], v116 offset:20480
  v_cvt_pk_bf16_f32 v94, v44, v45
  v_cvt_pk_bf16_f32 v95, v46, v47
  v_mfma_f32_16x16x16_bf16 v[40:43], v[92:93], v[102:103], 0
  ds_read_b128 v[140:143], v116 offset:21504
  v_cvt_pk_bf16_f32 v88, v32, v33
  v_cvt_pk_bf16_f32 v89, v34, v35
  v_mfma_f32_16x16x16_bf16 v[44:47], v[94:95], v[102:103], 0
  v_cvt_pk_bf16_f32 v90, v36, v37
  v_cvt_pk_bf16_f32 v91, v38, v39
  v_smfmac_f32_16x16x64_bf16 v[48:51], v[4:7], a[184:191], v104
  v_mfma_f32_16x16x32_bf16 v[32:35], v[56:59], v[88:91], 0
  v_cvt_pk_bf16_f32 v92, v40, v41
  v_cvt_pk_bf16_f32 v93, v42, v43
  v_mfma_f32_16x16x32_bf16 v[36:39], v[60:63], v[88:91], 0
  v_cvt_pk_bf16_f32 v94, v44, v45
  v_cvt_pk_bf16_f32 v95, v46, v47
  s_waitcnt lgkmcnt(4)
  v_smfmac_f32_16x16x64_bf16 v[48:51], v[12:15], v[120:127], v104
  ds_read_b128 v[120:123], v116 offset:24576
  v_mfma_f32_16x16x32_bf16 v[40:43], v[92:95], v[88:91], 0
  ds_read_b128 v[124:127], v116 offset:25600
  v_mov_b32_dpp v32, v36 quad_perm:[0,1,2,3] row_mask:0xf bank_mask:0xc
  v_mov_b32_dpp v33, v37 quad_perm:[0,1,2,3] row_mask:0xf bank_mask:0xc
  v_mov_b32_dpp v34, v38 quad_perm:[0,1,2,3] row_mask:0xf bank_mask:0xc
  v_mov_b32_dpp v35, v39 quad_perm:[0,1,2,3] row_mask:0xf bank_mask:0xc
  v_smfmac_f32_16x16x64_bf16 v[52:55], v[4:7], a[192:199], v104
  ds_write_b128 v106, v[32:35] offset:8192
  s_nop 0
  v_mov_b32_dpp v40, v42 quad_perm:[0,1,2,3] row_mask:0xf bank_mask:0xc
  v_mov_b32_dpp v41, v43 quad_perm:[0,1,2,3] row_mask:0xf bank_mask:0xc
  v_smfmac_f32_16x16x64_bf16 v[52:55], v[12:15], a[208:215], v104
  ds_write_b64 v110, v[40:41]
  s_waitcnt lgkmcnt(6)
  v_smfmac_f32_16x16x64_bf16 v[48:51], v[16:19], v[128:135], v104
  ds_read_b128 v[128:131], v116 offset:22528
  v_smfmac_f32_16x16x64_bf16 v[48:51], v[0:3], a[168:175], v104
  ds_read_b128 v[132:135], v116 offset:23552
  v_smfmac_f32_16x16x64_bf16 v[52:55], v[0:3], a[176:183], v104
  v_smfmac_f32_16x16x64_bf16 v[48:51], v[20:23], a[224:231], v104
  v_smfmac_f32_16x16x64_bf16 v[52:55], v[20:23], a[232:239], v104
  s_waitcnt lgkmcnt(2)
  s_barrier
  ds_read_b128 v[56:59], v107 offset:8192
  v_smfmac_f32_16x16x64_bf16 v[48:51], v[28:31], v[144:151], v104
  ds_read_b128 v[60:63], v108 offset:8192
  v_smfmac_f32_16x16x64_bf16 v[52:55], v[28:31], v[152:159], v104
  ds_read_b128 v[36:39], v109 offset:8192
  v_smfmac_f32_16x16x64_bf16 v[52:55], v[8:11], a[200:207], v104
  ds_read2_b64 v[40:43], v111 offset0:0 offset1:32
  v_smfmac_f32_16x16x64_bf16 v[52:55], v[16:19], a[216:223], v104
  ds_read2_b64 v[44:47], v111 offset0:64 offset1:96
  v_smfmac_f32_16x16x64_bf16 v[48:51], v[24:27], a[240:247], v104
  v_smfmac_f32_16x16x64_bf16 v[52:55], v[24:27], a[248:255], v104
  s_waitcnt lgkmcnt(4)
  v_pk_add_f32 v[56:57], v[56:57], v[32:33]
  v_pk_add_f32 v[58:59], v[58:59], v[34:35]
  s_waitcnt lgkmcnt(2)
  v_pk_add_f32 v[36:37], v[36:37], v[60:61]
  v_pk_add_f32 v[38:39], v[38:39], v[62:63]
  v_pk_add_f32 v[56:57], v[56:57], v[36:37]
  v_pk_add_f32 v[58:59], v[58:59], v[38:39]
  s_waitcnt lgkmcnt(0)
  v_pk_add_f32 v[40:41], v[40:41], v[42:43]
  v_pk_add_f32 v[44:45], v[44:45], v[46:47]
  v_max3_f32 v0, v56, v57, v58
  v_pk_add_f32 v[40:41], v[40:41], v[44:45]
  v_max_f32 v0, v0, v59
  v_max3_f32 v0, v0, v40, v41
  v_cvt_pk_bf16_f32 v60, v48, v49
  v_cvt_pk_bf16_f32 v61, v50, v51
  v_max_f32_dpp v0, v0, v0 row_ror:8 row_mask:0xf bank_mask:0xf
  v_mov_b32 v1, v0
  v_cvt_pk_bf16_f32 v62, v52, v53
  v_cvt_pk_bf16_f32 v63, v54, v55
  v_permlane16_swap_b32 v0, v1
  v_max_f32 v0, v0, v1
  v_mov_b32 v1, v0
  v_mov_b64 v[16:17], 0
  v_mov_b64 v[18:19], 0
  v_permlane32_swap_b32 v0, v1
  v_max_f32 v0, v0, v1
  v_mul_f32 v0, s58, v0
  v_pk_fma_f32 v[56:57], v[56:57], s[58:59], v[0:1] op_sel_hi:[1,1,0] neg_lo:[0,0,1] neg_hi:[0,0,1]
  v_pk_fma_f32 v[58:59], v[58:59], s[58:59], v[0:1] op_sel_hi:[1,1,0] neg_lo:[0,0,1] neg_hi:[0,0,1]
  v_pk_fma_f32 v[40:41], v[40:41], s[58:59], v[0:1] op_sel_hi:[1,1,0] neg_lo:[0,0,1] neg_hi:[0,0,1]
  v_exp_f32 v56, v56
  v_exp_f32 v57, v57
  v_exp_f32 v58, v58
  v_exp_f32 v59, v59
  v_exp_f32 v40, v40
  v_cvt_pk_bf16_f32 v88, v56, v57
  v_cvt_pk_bf16_f32 v89, v58, v59
  v_exp_f32 v41, v41
  v_mov_b32_dpp v90, v88 row_ror:8 row_mask:0xf bank_mask:0xf
  v_mov_b32_dpp v91, v89 row_ror:8 row_mask:0xf bank_mask:0xf
  v_cvt_pk_bf16_f32 v2, v40, v41
  v_pk_add_f32 v[56:57], v[56:57], v[58:59]
  v_mfma_f32_16x16x32_bf16 v[32:35], v[64:67], v[88:91], 0
  v_mov_b32_dpp v3, v2 row_ror:8 row_mask:0xf bank_mask:0xf
  v_add_f32 v40, v40, v41
  v_mfma_f32_16x16x32_bf16 v[36:39], v[68:71], v[88:91], 0
  v_add_f32 v56, v56, v57
  v_fma_f32 v0, v40, 0.5, v56
  v_mfma_f32_16x16x16_bf16 v[32:35], v[60:61], v[2:3], v[32:35]
  s_nop 0
  v_add_f32_dpp v0, v0, v0 row_ror:8 row_mask:0xf bank_mask:0xf
  v_mov_b32 v1, v0
  v_mfma_f32_16x16x16_bf16 v[36:39], v[62:63], v[2:3], v[36:39]
  s_nop 0
  v_permlane16_swap_b32 v0, v1
  v_add_f32 v0, v0, v1
  v_mov_b32 v1, v0
  v_mov_b64 v[20:21], 0
  v_mov_b64 v[22:23], 0
  v_permlane32_swap_b32 v0, v1
  v_add_f32 v0, v0, v1
  v_rcp_f32 v0, v0
  v_mov_b64 v[24:25], 0
  v_pk_mul_f32 v[32:33], v[32:33], v[0:1] op_sel_hi:[1,0]
  v_pk_mul_f32 v[34:35], v[34:35], v[0:1] op_sel_hi:[1,0]
  v_pk_mul_f32 v[36:37], v[36:37], v[0:1] op_sel_hi:[1,0]
  v_pk_mul_f32 v[38:39], v[38:39], v[0:1] op_sel_hi:[1,0]
  v_cvt_pk_bf16_f32 v88, v32, v33
  v_cvt_pk_bf16_f32 v89, v34, v35
  v_cvt_pk_bf16_f32 v90, v36, v37
  v_cvt_pk_bf16_f32 v91, v38, v39
  ds_write_b128 v112, v[88:91] offset:9216
  v_mov_b32_dpp v88, v88 row_ror:8 row_mask:0xf bank_mask:0xc
  v_mov_b32_dpp v89, v89 row_ror:8 row_mask:0xf bank_mask:0xc
  v_mov_b32_dpp v90, v90 row_ror:8 row_mask:0xf bank_mask:0xc
  v_mov_b32_dpp v91, v91 row_ror:8 row_mask:0xf bank_mask:0xc
  v_mov_b64 v[26:27], 0
  v_mov_b64 v[28:29], 0
  v_mov_b64 v[30:31], 0
  v_mov_b64 v[48:49], 0
  v_mov_b64 v[50:51], 0
  v_mov_b64 v[52:53], 0
  v_mov_b64 v[54:55], 0
  s_mov_b32 s49, s45
  s_add_u32 s45, s45, 0x2000
  v_smfmac_f32_16x16x64_bf16 v[16:19], v[88:91], v[160:167], v104
  s_waitcnt lgkmcnt(0)
  s_barrier
  ds_read_b128 v[4:7], v100 offset:9216
  v_smfmac_f32_16x16x64_bf16 v[20:23], v[88:91], v[192:199], v104
  ds_read_b128 v[8:11], v101 offset:9216
  v_smfmac_f32_16x16x64_bf16 v[24:27], v[88:91], v[136:143], v104
  ds_read_b128 v[12:15], v118 offset:9216
  v_smfmac_f32_16x16x64_bf16 v[28:31], v[88:91], v[232:239], v104
  ds_read_b128 v[136:139], v116 offset:26624
  s_waitcnt lgkmcnt(3)
  v_smfmac_f32_16x16x64_bf16 v[16:19], v[4:7], v[168:175], v104
  ds_read_b128 v[140:143], v116 offset:27648
  v_mov_b64 v[40:41], 0
  s_waitcnt lgkmcnt(3)
  v_smfmac_f32_16x16x64_bf16 v[16:19], v[8:11], v[176:183], v104
  v_mov_b64 v[42:43], 0
  s_waitcnt lgkmcnt(2)
  v_smfmac_f32_16x16x64_bf16 v[16:19], v[12:15], v[184:191], v104
  v_mov_b64 v[44:45], 0
  v_smfmac_f32_16x16x64_bf16 v[20:23], v[4:7], v[200:207], v104
  v_mov_b64 v[46:47], 0
  v_smfmac_f32_16x16x64_bf16 v[20:23], v[8:11], v[120:127], v104
  ds_read_b128 v[120:123], v116 offset:16384
  v_cvt_pk_bf16_f32 v32, v16, v17
  v_cvt_pk_bf16_f32 v33, v18, v19
  v_bfi_b32 v32, 1, s43, v32
  v_smfmac_f32_16x16x64_bf16 v[20:23], v[12:15], v[208:215], v104
  buffer_store_dwordx2 v[32:33], v114, s[8:11], s46 offen offset:0
  v_smfmac_f32_16x16x64_bf16 v[24:27], v[4:7], v[128:135], v104
  ds_read_b128 v[124:127], v116 offset:17408
  v_mov_b64 v[16:17], 0
  v_smfmac_f32_16x16x64_bf16 v[24:27], v[8:11], v[216:223], v104
  ds_read_b128 v[128:131], v116 offset:8192
  v_cvt_pk_bf16_f32 v34, v20, v21
  v_cvt_pk_bf16_f32 v35, v22, v23
  v_bfi_b32 v34, 1, s43, v34
  v_smfmac_f32_16x16x64_bf16 v[24:27], v[12:15], v[224:231], v104
  buffer_store_dwordx2 v[34:35], v114, s[8:11], s46 offen offset:2048
  v_smfmac_f32_16x16x64_bf16 v[28:31], v[4:7], v[240:247], v104
  ds_read_b128 v[132:135], v116 offset:9216
  v_mov_b64 v[18:19], 0
  v_smfmac_f32_16x16x64_bf16 v[28:31], v[8:11], v[248:255], v104
  s_nop 0
  v_cvt_pk_bf16_f32 v36, v24, v25
  v_cvt_pk_bf16_f32 v37, v26, v27
  v_bfi_b32 v36, 1, s43, v36
  s_waitcnt lgkmcnt(4)
  v_smfmac_f32_16x16x64_bf16 v[28:31], v[12:15], v[136:143], v104
  buffer_store_dwordx2 v[36:37], v114, s[8:11], s47 offen offset:0
  ds_read_b128 v[136:139], v116 offset:18432
  ds_read_b128 v[140:143], v116 offset:19456
  s_mov_b32 s54, 1048576
  s_add_u32 s52, s52, 0x2000
  s_and_b32 s52, s52, 0xffff7fff
  s_add_u32 s42, s42, 1
  v_mov_b64 v[32:33], 0
  v_mov_b64 v[34:35], 0
  v_cvt_pk_bf16_f32 v38, v28, v29
  v_cvt_pk_bf16_f32 v39, v30, v31
  v_bfi_b32 v38, 1, s43, v38
  buffer_store_dwordx2 v[38:39], v114, s[8:11], s47 offen offset:2048
  s_cmp_lt_u32 s41, 2
  s_cbranch_scc1 L_early_b
  s_nop 15
  s_nop 15
  s_nop 13
L_early_b:
  v_mov_b64 v[36:37], 0
  v_mov_b64 v[38:39], 0
  s_nop 15
  s_nop 9
  buffer_load_dwordx4 v[8:11], v105, s[8:11], s48 offen sc1
  buffer_load_dwordx4 v[12:15], v105, s[8:11], s48 offen offset:1024 sc1
  s_nop 15
  s_nop 3
  buffer_load_dwordx4 v[20:23], v105, s[8:11], s48 offen sc1
  buffer_load_dwordx4 v[24:27], v105, s[8:11], s48 offen offset:1024 sc1
  s_cmp_eq_u32 s42, 63
L_h1w_b:
  s_waitcnt vmcnt(2)
  v_smfmac_f32_16x16x64_bf16 v[16:19], v[96:99], v[8:15], v117
  v_bitop3_b32 v95, v8, v10, s43 bitop3:0x7e
  v_bitop3_b32 v94, v12, v14, s43 bitop3:0x7e
  v_bitop3_b32 v95, v95, v94, 1 bitop3:0xa8
  v_cmp_ne_u32 vcc, 0, v95
  v_mov_b32 v95, -1
  s_cbranch_vccnz L_h1r0_b
L_h1ok_b:
  v_mov_b64 v[56:57], v[72:73]
  s_nop 0
  v_add_f32_dpp v16, v16, v16 row_ror:4 row_mask:0xf bank_mask:0xf
  v_add_f32_dpp v17, v17, v17 row_ror:4 row_mask:0xf bank_mask:0xf
  s_nop 0
  v_add_f32_dpp v16, v16, v16 row_ror:8 row_mask:0xf bank_mask:0xf
  v_add_f32_dpp v17, v17, v17 row_ror:8 row_mask:0xf bank_mask:0xf
  v_cvt_pk_bf16_f32 v113, v16, v17
  v_min_u32 v113, -2, v113
  s_cbranch_scc1 L_chain_done
  buffer_store_dword v113, v115, s[8:11], s51 offen
  buffer_store_dword v95, v115, s[8:11], s53 offen
  s_cmp_lt_u32 s41, 2
  s_cbranch_scc1 L_early2_b
L_late2_b:
  buffer_load_dwordx4 v105, s[8:11], s52 offen sc1 lds
  v_mov_b64 v[58:59], v[74:75]
  v_mov_b64 v[60:61], v[76:77]
  v_mov_b64 v[62:63], v[78:79]
  v_mov_b64 v[64:65], v[80:81]
  v_mov_b64 v[66:67], v[82:83]
  v_mov_b64 v[68:69], v[84:85]
  v_mov_b64 v[70:71], v[86:87]
  s_xor_b32 s43, s43, 1
  s_add_u32 s51, s51, 0x2000
  s_and_b32 s51, s51, 0xffff7fff
  s_add_u32 s53, s53, 0x2000
  s_and_b32 s53, s53, 0xffff7fff
  s_mov_b32 s54, 1048576
  s_waitcnt lgkmcnt(0)
  s_nop 15
  s_nop 7
  buffer_load_dwordx4 v105, s[8:11], s52 offen sc1 lds
  s_nop 13
  buffer_load_dwordx4 v105, s[8:11], s52 offen offset:1024 sc1 lds
  s_waitcnt vmcnt(2)
  ds_read_b128 v[0:3], v106 offset:0
  s_branch L_ew_b
L_h1r0_b:
  s_mov_b64 exec, vcc
  buffer_load_dwordx4 v[8:11], v105, s[8:11], s48 offen sc1
  buffer_load_dwordx4 v[12:15], v105, s[8:11], s48 offen offset:1024 sc1
  s_mov_b64 exec, -1
  s_sub_u32 s54, s54, 1
  s_cbranch_scc1 L_fail
  s_cmp_eq_u32 s42, 63
  v_mov_b64 v[16:17], 0
  v_mov_b64 v[18:19], 0
  s_waitcnt vmcnt(2)
  s_nop 0
  v_smfmac_f32_16x16x64_bf16 v[16:19], v[96:99], v[20:27], v117
  v_bitop3_b32 v95, v20, v22, s43 bitop3:0x7e
  v_bitop3_b32 v94, v24, v26, s43 bitop3:0x7e
  v_bitop3_b32 v95, v95, v94, 1 bitop3:0xa8
  v_cmp_ne_u32 vcc, 0, v95
  v_mov_b32 v95, -1
  s_cbranch_vccz L_h1ok_b
L_h1r1_b:
  s_mov_b64 exec, vcc
  buffer_load_dwordx4 v[20:23], v105, s[8:11], s48 offen sc1
  buffer_load_dwordx4 v[24:27], v105, s[8:11], s48 offen offset:1024 sc1
  s_mov_b64 exec, -1
  s_sub_u32 s54, s54, 1
  s_cbranch_scc1 L_fail
  s_cmp_eq_u32 s42, 63
  v_mov_b64 v[16:17], 0
  v_mov_b64 v[18:19], 0
  s_branch L_h1w_b
L_early2_b:
  s_nop 15
  s_nop 15
  s_nop 1
  s_branch L_late2_b
L_retry3_b:
  s_mov_b64 exec, vcc
  buffer_load_dwordx4 v105, s[8:11], s52 offen offset:1024 sc1 lds
  s_sub_u32 s54, s54, 1
  s_cbranch_scc1 L_fail
  s_waitcnt vmcnt(1)
  ds_read_b128 v[4:7], v106 offset:1024
  s_waitcnt lgkmcnt(0)
  v_max3_u32 v95, v4, v5, v6
  v_max_u32 v95, v95, v7
  v_cmp_eq_u32 vcc, -1, v95
  s_cbranch_vccnz L_retry3_b
  s_mov_b64 exec, -1
  s_branch L_ret3_b
L_chain_done:
  buffer_store_dword v113, v115, s[8:11], s51 offen
  s_waitcnt lgkmcnt(0)
  ds_read_b128 v[120:123], v116 offset:8192
  ds_read_b128 v[124:127], v116 offset:9216
  ds_read_b128 v[128:131], v116 offset:10240
  ds_read_b128 v[132:135], v116 offset:11264
  ds_read_b128 v[136:139], v116 offset:2048
  ds_read_b128 v[140:143], v116 offset:3072
  ds_read_b128 v[56:59], v116 offset:6144
  ds_read_b128 v[60:63], v116 offset:7168
  s_waitcnt lgkmcnt(0)
  ds_read_b128 v[64:67], v116 offset:32768
  ds_read_b128 v[68:71], v116 offset:33792
  ds_read_b128 v[72:75], v116 offset:0
  ds_read_b128 v[76:79], v116 offset:1024
  ds_read_b128 v[80:83], v116 offset:28672
  ds_read_b128 v[84:87], v116 offset:29696
  ds_read_b128 v[160:163], v116 offset:30720
  ds_read_b128 v[164:167], v116 offset:31744
  s_waitcnt lgkmcnt(0)
  s_lshl_b32 s55, s40, 8
  s_add_u32 s55, s55, s41
  s_lshl_b32 s55, s55, 10
  s_add_u32 s55, s55, 0x383f000
  s_mov_b32 s54, 1048576
  s_mov_b64 vcc, -1
L_fin_r:
  s_mov_b64 exec, vcc
  buffer_load_dwordx4 v105, s[8:11], s52 offen sc1 lds
  buffer_load_dwordx4 v105, s[8:11], s52 offen offset:1024 sc1 lds
  s_sub_u32 s54, s54, 1
  s_cbranch_scc1 L_fail
  s_waitcnt vmcnt(0)
  ds_read_b128 v[0:3], v106 offset:0
  ds_read_b128 v[4:7], v106 offset:1024
  s_waitcnt lgkmcnt(0)
  v_max3_u32 v95, v0, v1, v2
  v_max3_u32 v94, v3, v4, v5
  v_max3_u32 v95, v95, v6, v7
  v_max_u32 v95, v95, v94
  v_cmp_eq_u32 vcc, -1, v95
  s_cbranch_vccnz L_fin_r
  s_mov_b64 exec, -1
  s_barrier
  v_smfmac_f32_16x16x64_bf16 v[40:43], v[0:3], v[120:127], v104
  ds_read_b128 v[8:11], v107 offset:0
  v_smfmac_f32_16x16x64_bf16 v[44:47], v[0:3], a[80:87], v104
  ds_read_b128 v[12:15], v107 offset:1024
  v_smfmac_f32_16x16x64_bf16 v[40:43], v[4:7], a[88:95], v104
  ds_read_b128 v[16:19], v108 offset:0
  v_smfmac_f32_16x16x64_bf16 v[44:47], v[4:7], a[96:103], v104
  ds_read_b128 v[20:23], v108 offset:1024
  v_smfmac_f32_16x16x64_bf16 v[48:51], v[0:3], a[168:175], v104
  ds_read_b128 v[24:27], v109 offset:0
  v_smfmac_f32_16x16x64_bf16 v[52:55], v[0:3], a[176:183], v104
  ds_read_b128 v[28:31], v109 offset:1024
  s_waitcnt lgkmcnt(5)
  v_smfmac_f32_16x16x64_bf16 v[40:43], v[8:11], a[104:111], v104
  v_smfmac_f32_16x16x64_bf16 v[44:47], v[8:11], v[128:135], v104
  s_waitcnt lgkmcnt(4)
  v_smfmac_f32_16x16x64_bf16 v[40:43], v[12:15], a[112:119], v104
  v_smfmac_f32_16x16x64_bf16 v[44:47], v[12:15], v[56:63], v104
  s_waitcnt lgkmcnt(3)
  v_smfmac_f32_16x16x64_bf16 v[40:43], v[16:19], a[120:127], v104
  v_smfmac_f32_16x16x64_bf16 v[44:47], v[16:19], a[128:135], v104
  s_waitcnt lgkmcnt(2)
  v_smfmac_f32_16x16x64_bf16 v[40:43], v[20:23], a[136:143], v104
  v_smfmac_f32_16x16x64_bf16 v[44:47], v[20:23], a[144:151], v104
  s_waitcnt lgkmcnt(1)
  v_smfmac_f32_16x16x64_bf16 v[40:43], v[24:27], v[136:143], v104
  v_smfmac_f32_16x16x64_bf16 v[44:47], v[24:27], a[152:159], v104
  s_waitcnt lgkmcnt(0)
  v_smfmac_f32_16x16x64_bf16 v[40:43], v[28:31], v[64:71], v104
  v_smfmac_f32_16x16x64_bf16 v[44:47], v[28:31], a[160:167], v104
  v_smfmac_f32_16x16x64_bf16 v[48:51], v[4:7], a[184:191], v104
  v_smfmac_f32_16x16x64_bf16 v[52:55], v[4:7], a[192:199], v104
  v_smfmac_f32_16x16x64_bf16 v[48:51], v[8:11], v[72:79], v104
  v_cvt_pk_bf16_f32 v88, v40, v41
  v_cvt_pk_bf16_f32 v89, v42, v43
  v_cvt_pk_bf16_f32 v90, v44, v45
  v_cvt_pk_bf16_f32 v91, v46, v47
  v_smfmac_f32_16x16x64_bf16 v[52:55], v[8:11], a[200:207], v104
  v_mfma_f32_16x16x16_bf16 v[40:43], v[88:89], v[102:103], 0
  v_mfma_f32_16x16x16_bf16 v[44:47], v[90:91], v[102:103], 0
  v_smfmac_f32_16x16x64_bf16 v[48:51], v[12:15], v[80:87], v104
  v_smfmac_f32_16x16x64_bf16 v[52:55], v[12:15], a[208:215], v104
  v_smfmac_f32_16x16x64_bf16 v[48:51], v[16:19], v[160:167], v104
  v_smfmac_f32_16x16x64_bf16 v[52:55], v[16:19], a[216:223], v104
  v_cvt_pk_bf16_f32 v88, v40, v41
  v_cvt_pk_bf16_f32 v89, v42, v43
  v_cvt_pk_bf16_f32 v90, v44, v45
  v_cvt_pk_bf16_f32 v91, v46, v47
  v_smfmac_f32_16x16x64_bf16 v[48:51], v[20:23], a[224:231], v104
  v_smfmac_f32_16x16x64_bf16 v[52:55], v[20:23], a[232:239], v104
  v_mov_b32_dpp v88, v90 quad_perm:[0,1,2,3] row_mask:0xf bank_mask:0xc
  v_mov_b32_dpp v89, v91 quad_perm:[0,1,2,3] row_mask:0xf bank_mask:0xc
  v_min_u32 v88, -2, v88
  v_min_u32 v89, -2, v89
  v_smfmac_f32_16x16x64_bf16 v[48:51], v[24:27], a[240:247], v104
  v_smfmac_f32_16x16x64_bf16 v[52:55], v[24:27], a[248:255], v104
  v_smfmac_f32_16x16x64_bf16 v[48:51], v[28:31], v[144:151], v104
  v_smfmac_f32_16x16x64_bf16 v[52:55], v[28:31], v[152:159], v104
  s_nop 7
  v_permlane32_swap_b32 v48, v52
  v_permlane32_swap_b32 v49, v53
  v_permlane32_swap_b32 v50, v54
  v_permlane32_swap_b32 v51, v55
  v_add_f32 v48, v48, v52
  v_add_f32 v49, v49, v53
  v_add_f32 v50, v50, v54
  v_add_f32 v51, v51, v55
  v_cvt_pk_bf16_f32 v90, v48, v49
  v_cvt_pk_bf16_f32 v91, v50, v51
  v_min_u32 v90, -2, v90
  v_min_u32 v91, -2, v91
  buffer_store_dwordx4 v[88:91], v105, s[8:11], s55 offen sc1
L_chain_exit:
  s_branch L_end
L_rdy_2:
  s_mov_b32 s54, 1048576
L_rdy_2_p:
  v_mov_b32 v58, 64
  buffer_load_dword v58, v58, s[32:35], 0 offen sc1
  s_sub_u32 s54, s54, 1
  s_cbranch_scc1 L_fail
  s_waitcnt vmcnt(0)
  v_cmp_gt_u32 vcc, 256, v58
  s_cbranch_vccnz L_rdy_2_p
  s_branch L_rdy_2_ret
L_kv_3_slow:
  s_mov_b32 s54, 1048576
L_kv_3_p:
  s_mov_b64 exec, 15
  buffer_load_dword v55, v54, s[8:11], s62 offen sc1
  s_mov_b64 exec, -1
  s_sub_u32 s54, s54, 1
  s_cbranch_scc1 L_fail
  s_waitcnt vmcnt(0)
  v_cmp_ge_u32 vcc, s55, v55
  s_nop 0
  s_and_b32 s56, vcc_lo, 15
  s_cbranch_scc0 L_kv_3_ret
  s_sleep 2
  s_branch L_kv_3_p
L_kv_5_slow:
  s_mov_b32 s54, 1048576
L_kv_5_p:
  s_mov_b64 exec, 15
  buffer_load_dword v119, v105, s[8:11], s62 offen sc1
  s_mov_b64 exec, -1
  s_sub_u32 s54, s54, 1
  s_cbranch_scc1 L_fail
  s_waitcnt vmcnt(0)
  v_cmp_ge_u32 vcc, s55, v119
  s_nop 0
  s_and_b32 s56, vcc_lo, 15
  s_cbranch_scc0 L_kv_5_ret
  s_sleep 2
  s_branch L_kv_5_p
L_spw:
  s_max_u32 s50, s50, 1
L_worker:
  s_sub_u32 s55, s50, 2
  s_lshl_b32 s55, s55, 5
  s_add_u32 s55, s55, s51
  s_mul_i32 s40, s55, 10923
  s_lshr_b32 s40, s40, 16
  s_mul_i32 s56, s40, 6
  s_sub_u32 s42, s55, s56
  s_cmp_eq_u32 s50, 1
  s_cselect_b32 s40, s51, s40
  s_cselect_b32 s42, 6, s42
  v_lshlrev_b32 v1, 4, v0
  s_mul_i32 s57, s41, 24576
  s_add_u32 s57, s57, 65536
  s_lshl_b32 s55, s40, 2
  s_add_u32 s55, s55, s41
  s_lshl_b32 s55, s55, 3
  s_add_u32 s55, s55, s42
  s_lshl_b32 s55, s55, 4
  s_add_u32 s55, s55, 0x40a4000
  v_mov_b32 v7, 0
  v_mov_b32 v6, 0
  s_mov_b64 exec, 1
  buffer_store_dword v7, v6, s[8:11], s55 offen sc1
  s_mov_b64 exec, -1
  s_lshl_b32 s55, s40, 3
  s_add_u32 s55, s55, s42
  s_lshl_b32 s55, s55, 2
  s_add_u32 s55, s55, 0x40a1400
  v_mov_b32 v7, 0
  v_mov_b32 v6, 0
  s_mov_b64 exec, 1
  buffer_store_dword v7, v6, s[8:11], s55 offen sc1
  s_mov_b64 exec, -1
  s_sub_u32 s55, s55, 0x400
  v_mov_b32 v7, 0
  v_mov_b32 v6, 0
  s_mov_b64 exec, 1
  buffer_store_dword v7, v6, s[8:11], s55 offen sc1
  s_mov_b64 exec, -1
  s_sub_u32 s55, s50, 1
  s_lshl_b32 s55, s55, 5
  s_add_u32 s55, s55, s51
  s_lshl_b32 s55, s55, 2
  s_add_u32 s55, s55, s41
  s_and_b32 s55, s55, 511
  s_lshl_b32 s55, s55, 10
  s_add_u32 s55, s55, 0x3000000
  buffer_store_dwordx4 v[8:11], v1, s[8:11], s55 offen sc1
  s_cmp_lg_u32 s50, 1
  s_cbranch_scc1 L_wk3
  s_waitcnt vmcnt(0)
  s_barrier
  s_cmp_lg_u32 s41, 0
  s_cbranch_scc1 L_ra_7
  v_mov_b32 v6, 64
  v_mov_b32 v7, 1
  s_mov_b64 exec, 1
  buffer_atomic_add v7, v6, s[32:35], 0 offen sc1
  s_mov_b64 exec, -1
L_ra_7:
  s_mov_b32 s16, s70
  s_and_b32 s17, s71, 0xffff
  s_mov_b32 s18, 0x400000
  s_mov_b32 s19, 0x00020000
  s_mov_b32 s20, s72
  s_and_b32 s21, s73, 0xffff
  s_mov_b32 s22, 0x400000
  s_mov_b32 s23, 0x00020000
  s_barrier
  v_lshrrev_b32 v6, 2, v0
  v_and_b32 v7, 3, v0
  v_lshlrev_b32 v2, 4, v7
  v_lshl_add_u32 v2, v6, 13, v2
  s_lshl_b32 s55, s40, 8
  s_lshl_b32 s56, s41, 6
  s_add_u32 s55, s55, s56
  v_add_u32 v2, s55, v2
  v_lshrrev_b32 v3, 4, v0
  v_lshlrev_b32 v3, 3, v3
  v_and_b32 v6, 3, v6
  v_add_u32 v3, v3, v6
  v_lshlrev_b32 v3, 6, v3
  v_lshl_add_u32 v3, v7, 3, v3
  v_add_u32 v3, s57, v3
  s_mov_b32 s36, s80
  s_and_b32 s37, s81, 0xffff
  s_mov_b32 s38, 0x180000
  s_mov_b32 s39, 0x00020000
  s_cmp_eq_u32 s41, 3
  s_cbranch_scc1 L_ks_nb
  v_lshrrev_b32 v6, 2, v0
  v_mul_u32_u24 v9, 3072, v6
  v_and_b32 v7, 3, v0
  v_lshl_add_u32 v9, v7, 4, v9
  s_lshl_b32 s55, s41, 10
  s_and_b32 s4, s40, 30
  s_lshl_b32 s56, s4, 5
  s_add_u32 s55, s55, s56
  s_and_b32 s5, s40, 1
  s_mul_i32 s56, s5, 786432
  s_add_u32 s55, s55, s56
  s_add_u32 m0, s57, 0
  s_nop 0
  buffer_load_dwordx4 v9, s[36:39], s55 offen lds
  s_add_u32 s55, s55, 49152
  s_add_u32 m0, s57, 1024
  s_nop 0
  buffer_load_dwordx4 v9, s[36:39], s55 offen lds
  s_add_u32 s55, s55, 49152
  s_add_u32 m0, s57, 2048
  s_nop 0
  buffer_load_dwordx4 v9, s[36:39], s55 offen lds
  s_add_u32 s55, s55, 49152
  s_add_u32 m0, s57, 3072
  s_nop 0
  buffer_load_dwordx4 v9, s[36:39], s55 offen lds
  s_add_u32 s55, s55, 49152
  s_add_u32 m0, s57, 4096
  s_nop 0
  buffer_load_dwordx4 v9, s[36:39], s55 offen lds
  s_add_u32 s55, s55, 49152
  s_add_u32 m0, s57, 5120
  s_nop 0
  buffer_load_dwordx4 v9, s[36:39], s55 offen lds
  s_add_u32 s55, s55, 49152
  s_add_u32 m0, s57, 6144
  s_nop 0
  buffer_load_dwordx4 v9, s[36:39], s55 offen lds
  s_add_u32 s55, s55, 49152
  s_add_u32 m0, s57, 7168
  s_nop 0
  buffer_load_dwordx4 v9, s[36:39], s55 offen lds
  s_add_u32 s55, s55, 49152
  s_add_u32 m0, s57, 8192
  s_nop 0
  buffer_load_dwordx4 v9, s[36:39], s55 offen lds
  s_add_u32 s55, s55, 49152
  s_add_u32 m0, s57, 9216
  s_nop 0
  buffer_load_dwordx4 v9, s[36:39], s55 offen lds
  s_add_u32 s55, s55, 49152
  s_add_u32 m0, s57, 10240
  s_nop 0
  buffer_load_dwordx4 v9, s[36:39], s55 offen lds
  s_add_u32 s55, s55, 49152
  s_add_u32 m0, s57, 11264
  s_nop 0
  buffer_load_dwordx4 v9, s[36:39], s55 offen lds
  s_add_u32 s55, s55, 49152
  s_add_u32 m0, s57, 12288
  s_nop 0
  buffer_load_dwordx4 v9, s[36:39], s55 offen lds
  s_add_u32 s55, s55, 49152
  s_add_u32 m0, s57, 13312
  s_nop 0
  buffer_load_dwordx4 v9, s[36:39], s55 offen lds
  s_add_u32 s55, s55, 49152
  s_add_u32 m0, s57, 14336
  s_nop 0
  buffer_load_dwordx4 v9, s[36:39], s55 offen lds
  s_add_u32 s55, s55, 49152
  s_add_u32 m0, s57, 15360
  s_nop 0
  buffer_load_dwordx4 v9, s[36:39], s55 offen lds
  s_add_u32 s55, s55, 49152
  s_waitcnt vmcnt(0)
  ds_read_b64_tr_b16 v[80:81], v3 offset:0
  ds_read_b64_tr_b16 v[82:83], v3 offset:256
  ds_read_b64_tr_b16 v[84:85], v3 offset:2048
  ds_read_b64_tr_b16 v[86:87], v3 offset:2304
  ds_read_b64_tr_b16 v[88:89], v3 offset:4096
  ds_read_b64_tr_b16 v[90:91], v3 offset:4352
  ds_read_b64_tr_b16 v[92:93], v3 offset:6144
  ds_read_b64_tr_b16 v[94:95], v3 offset:6400
  s_waitcnt lgkmcnt(0)
  ds_read_b64_tr_b16 v[96:97], v3 offset:8192
  ds_read_b64_tr_b16 v[98:99], v3 offset:8448
  ds_read_b64_tr_b16 v[100:101], v3 offset:10240
  ds_read_b64_tr_b16 v[102:103], v3 offset:10496
  ds_read_b64_tr_b16 v[104:105], v3 offset:12288
  ds_read_b64_tr_b16 v[106:107], v3 offset:12544
  ds_read_b64_tr_b16 v[108:109], v3 offset:14336
  ds_read_b64_tr_b16 v[110:111], v3 offset:14592
  s_waitcnt lgkmcnt(0)
  ds_read_b64_tr_b16 v[112:113], v3 offset:32
  ds_read_b64_tr_b16 v[114:115], v3 offset:288
  ds_read_b64_tr_b16 v[116:117], v3 offset:2080
  ds_read_b64_tr_b16 v[118:119], v3 offset:2336
  ds_read_b64_tr_b16 v[120:121], v3 offset:4128
  ds_read_b64_tr_b16 v[122:123], v3 offset:4384
  ds_read_b64_tr_b16 v[124:125], v3 offset:6176
  ds_read_b64_tr_b16 v[126:127], v3 offset:6432
  s_waitcnt lgkmcnt(0)
  ds_read_b64_tr_b16 v[128:129], v3 offset:8224
  ds_read_b64_tr_b16 v[130:131], v3 offset:8480
  ds_read_b64_tr_b16 v[132:133], v3 offset:10272
  ds_read_b64_tr_b16 v[134:135], v3 offset:10528
  ds_read_b64_tr_b16 v[136:137], v3 offset:12320
  ds_read_b64_tr_b16 v[138:139], v3 offset:12576
  ds_read_b64_tr_b16 v[140:141], v3 offset:14368
  ds_read_b64_tr_b16 v[142:143], v3 offset:14624
  s_waitcnt lgkmcnt(0)
  s_lshl_b32 s4, s4, 1
  s_add_u32 s4, s4, s41
  s_lshl_b32 s4, s4, 15
  s_lshl_b32 s5, s5, 13
  s_add_u32 s4, s4, s5
  s_add_u32 s4, s4, 0x3400000
  buffer_store_dwordx4 v[80:83], v1, s[8:11], s4 offen offset:0 sc1
  buffer_store_dwordx4 v[84:87], v1, s[8:11], s4 offen offset:1024 sc1
  buffer_store_dwordx4 v[88:91], v1, s[8:11], s4 offen offset:2048 sc1
  buffer_store_dwordx4 v[92:95], v1, s[8:11], s4 offen offset:3072 sc1
  s_add_u32 s4, s4, 4096
  buffer_store_dwordx4 v[96:99], v1, s[8:11], s4 offen offset:0 sc1
  buffer_store_dwordx4 v[100:103], v1, s[8:11], s4 offen offset:1024 sc1
  buffer_store_dwordx4 v[104:107], v1, s[8:11], s4 offen offset:2048 sc1
  buffer_store_dwordx4 v[108:111], v1, s[8:11], s4 offen offset:3072 sc1
  s_add_u32 s4, s4, 12288
  buffer_store_dwordx4 v[112:115], v1, s[8:11], s4 offen offset:0 sc1
  buffer_store_dwordx4 v[116:119], v1, s[8:11], s4 offen offset:1024 sc1
  buffer_store_dwordx4 v[120:123], v1, s[8:11], s4 offen offset:2048 sc1
  buffer_store_dwordx4 v[124:127], v1, s[8:11], s4 offen offset:3072 sc1
  s_add_u32 s4, s4, 4096
  buffer_store_dwordx4 v[128:131], v1, s[8:11], s4 offen offset:0 sc1
  buffer_store_dwordx4 v[132:135], v1, s[8:11], s4 offen offset:1024 sc1
  buffer_store_dwordx4 v[136:139], v1, s[8:11], s4 offen offset:2048 sc1
  buffer_store_dwordx4 v[140:143], v1, s[8:11], s4 offen offset:3072 sc1
  s_add_u32 s4, s4, 4096
L_ks_nb:
  v_bfe_u32 v6, v0, 5, 1
  v_lshlrev_b32 v8, 4, v6
  v_bfe_u32 v6, v0, 4, 1
  v_lshl_add_u32 v8, v6, 2, v8
  v_bfe_u32 v6, v0, 3, 1
  v_lshl_add_u32 v8, v6, 3, v8
  v_bfe_u32 v6, v0, 2, 1
  v_lshl_add_u32 v8, v6, 0, v8
  v_and_b32 v7, 3, v0
  v_lshlrev_b32 v8, 6, v8
  v_lshl_add_u32 v8, v7, 3, v8
  v_add_u32 v8, s57, v8
  s_mov_b32 s55, 0
  s_add_u32 m0, s57, 0
  s_nop 0
  buffer_load_dwordx4 v2, s[16:19], s55 offen lds
  s_mov_b32 s55, 131072
  s_add_u32 m0, s57, 1024
  s_nop 0
  buffer_load_dwordx4 v2, s[16:19], s55 offen lds
  s_mov_b32 s55, 262144
  s_add_u32 m0, s57, 2048
  s_nop 0
  buffer_load_dwordx4 v2, s[16:19], s55 offen lds
  s_mov_b32 s55, 393216
  s_add_u32 m0, s57, 3072
  s_nop 0
  buffer_load_dwordx4 v2, s[16:19], s55 offen lds
  s_mov_b32 s55, 524288
  s_add_u32 m0, s57, 4096
  s_nop 0
  buffer_load_dwordx4 v2, s[16:19], s55 offen lds
  s_mov_b32 s55, 655360
  s_add_u32 m0, s57, 5120
  s_nop 0
  buffer_load_dwordx4 v2, s[16:19], s55 offen lds
  s_mov_b32 s55, 786432
  s_add_u32 m0, s57, 6144
  s_nop 0
  buffer_load_dwordx4 v2, s[16:19], s55 offen lds
  s_mov_b32 s55, 917504
  s_add_u32 m0, s57, 7168
  s_nop 0
  buffer_load_dwordx4 v2, s[16:19], s55 offen lds
  s_waitcnt vmcnt(4)
  ds_read_b64_tr_b16 a[0:1], v8 offset:0
  ds_read_b64_tr_b16 a[2:3], v8 offset:128
  ds_read_b64_tr_b16 a[4:5], v8 offset:2048
  ds_read_b64_tr_b16 a[6:7], v8 offset:2176
  ds_read_b64_tr_b16 a[8:9], v8 offset:32
  ds_read_b64_tr_b16 a[10:11], v8 offset:160
  ds_read_b64_tr_b16 a[12:13], v8 offset:2080
  ds_read_b64_tr_b16 a[14:15], v8 offset:2208
  s_waitcnt lgkmcnt(0)
  s_mov_b32 s55, 1048576
  s_add_u32 m0, s57, 0
  s_nop 0
  buffer_load_dwordx4 v2, s[16:19], s55 offen lds
  s_mov_b32 s55, 1179648
  s_add_u32 m0, s57, 1024
  s_nop 0
  buffer_load_dwordx4 v2, s[16:19], s55 offen lds
  s_mov_b32 s55, 1310720
  s_add_u32 m0, s57, 2048
  s_nop 0
  buffer_load_dwordx4 v2, s[16:19], s55 offen lds
  s_mov_b32 s55, 1441792
  s_add_u32 m0, s57, 3072
  s_nop 0
  buffer_load_dwordx4 v2, s[16:19], s55 offen lds
  s_waitcnt vmcnt(4)
  ds_read_b64_tr_b16 a[16:17], v8 offset:4096
  ds_read_b64_tr_b16 a[18:19], v8 offset:4224
  ds_read_b64_tr_b16 a[20:21], v8 offset:6144
  ds_read_b64_tr_b16 a[22:23], v8 offset:6272
  ds_read_b64_tr_b16 a[24:25], v8 offset:4128
  ds_read_b64_tr_b16 a[26:27], v8 offset:4256
  ds_read_b64_tr_b16 a[28:29], v8 offset:6176
  ds_read_b64_tr_b16 a[30:31], v8 offset:6304
  s_waitcnt lgkmcnt(0)
  s_mov_b32 s55, 1572864
  s_add_u32 m0, s57, 4096
  s_nop 0
  buffer_load_dwordx4 v2, s[16:19], s55 offen lds
  s_mov_b32 s55, 1703936
  s_add_u32 m0, s57, 5120
  s_nop 0
  buffer_load_dwordx4 v2, s[16:19], s55 offen lds
  s_mov_b32 s55, 1835008
  s_add_u32 m0, s57, 6144
  s_nop 0
  buffer_load_dwordx4 v2, s[16:19], s55 offen lds
  s_mov_b32 s55, 1966080
  s_add_u32 m0, s57, 7168
  s_nop 0
  buffer_load_dwordx4 v2, s[16:19], s55 offen lds
  s_waitcnt vmcnt(4)
  ds_read_b64_tr_b16 a[32:33], v8 offset:0
  ds_read_b64_tr_b16 a[34:35], v8 offset:128
  ds_read_b64_tr_b16 a[36:37], v8 offset:2048
  ds_read_b64_tr_b16 a[38:39], v8 offset:2176
  ds_read_b64_tr_b16 a[40:41], v8 offset:32
  ds_read_b64_tr_b16 a[42:43], v8 offset:160
  ds_read_b64_tr_b16 a[44:45], v8 offset:2080
  ds_read_b64_tr_b16 a[46:47], v8 offset:2208
  s_waitcnt lgkmcnt(0)
  s_mov_b32 s55, 2097152
  s_add_u32 m0, s57, 0
  s_nop 0
  buffer_load_dwordx4 v2, s[16:19], s55 offen lds
  s_mov_b32 s55, 2228224
  s_add_u32 m0, s57, 1024
  s_nop 0
  buffer_load_dwordx4 v2, s[16:19], s55 offen lds
  s_mov_b32 s55, 2359296
  s_add_u32 m0, s57, 2048
  s_nop 0
  buffer_load_dwordx4 v2, s[16:19], s55 offen lds
  s_mov_b32 s55, 2490368
  s_add_u32 m0, s57, 3072
  s_nop 0
  buffer_load_dwordx4 v2, s[16:19], s55 offen lds
  s_waitcnt vmcnt(4)
  ds_read_b64_tr_b16 a[48:49], v8 offset:4096
  ds_read_b64_tr_b16 a[50:51], v8 offset:4224
  ds_read_b64_tr_b16 a[52:53], v8 offset:6144
  ds_read_b64_tr_b16 a[54:55], v8 offset:6272
  ds_read_b64_tr_b16 a[56:57], v8 offset:4128
  ds_read_b64_tr_b16 a[58:59], v8 offset:4256
  ds_read_b64_tr_b16 a[60:61], v8 offset:6176
  ds_read_b64_tr_b16 a[62:63], v8 offset:6304
  s_waitcnt lgkmcnt(0)
  s_mov_b32 s55, 2621440
  s_add_u32 m0, s57, 4096
  s_nop 0
  buffer_load_dwordx4 v2, s[16:19], s55 offen lds
  s_mov_b32 s55, 2752512
  s_add_u32 m0, s57, 5120
  s_nop 0
  buffer_load_dwordx4 v2, s[16:19], s55 offen lds
  s_mov_b32 s55, 2883584
  s_add_u32 m0, s57, 6144
  s_nop 0
  buffer_load_dwordx4 v2, s[16:19], s55 offen lds
  s_mov_b32 s55, 3014656
  s_add_u32 m0, s57, 7168
  s_nop 0
  buffer_load_dwordx4 v2, s[16:19], s55 offen lds
  s_waitcnt vmcnt(4)
  ds_read_b64_tr_b16 a[64:65], v8 offset:0
  ds_read_b64_tr_b16 a[66:67], v8 offset:128
  ds_read_b64_tr_b16 a[68:69], v8 offset:2048
  ds_read_b64_tr_b16 a[70:71], v8 offset:2176
  ds_read_b64_tr_b16 a[72:73], v8 offset:32
  ds_read_b64_tr_b16 a[74:75], v8 offset:160
  ds_read_b64_tr_b16 a[76:77], v8 offset:2080
  ds_read_b64_tr_b16 a[78:79], v8 offset:2208
  s_waitcnt lgkmcnt(0)
  s_mov_b32 s55, 3145728
  s_add_u32 m0, s57, 0
  s_nop 0
  buffer_load_dwordx4 v2, s[16:19], s55 offen lds
  s_mov_b32 s55, 3276800
  s_add_u32 m0, s57, 1024
  s_nop 0
  buffer_load_dwordx4 v2, s[16:19], s55 offen lds
  s_mov_b32 s55, 3407872
  s_add_u32 m0, s57, 2048
  s_nop 0
  buffer_load_dwordx4 v2, s[16:19], s55 offen lds
  s_mov_b32 s55, 3538944
  s_add_u32 m0, s57, 3072
  s_nop 0
  buffer_load_dwordx4 v2, s[16:19], s55 offen lds
  s_waitcnt vmcnt(4)
  ds_read_b64_tr_b16 a[80:81], v8 offset:4096
  ds_read_b64_tr_b16 a[82:83], v8 offset:4224
  ds_read_b64_tr_b16 a[84:85], v8 offset:6144
  ds_read_b64_tr_b16 a[86:87], v8 offset:6272
  ds_read_b64_tr_b16 a[88:89], v8 offset:4128
  ds_read_b64_tr_b16 a[90:91], v8 offset:4256
  ds_read_b64_tr_b16 a[92:93], v8 offset:6176
  ds_read_b64_tr_b16 a[94:95], v8 offset:6304
  s_waitcnt lgkmcnt(0)
  s_mov_b32 s55, 3670016
  s_add_u32 m0, s57, 4096
  s_nop 0
  buffer_load_dwordx4 v2, s[16:19], s55 offen lds
  s_mov_b32 s55, 3801088
  s_add_u32 m0, s57, 5120
  s_nop 0
  buffer_load_dwordx4 v2, s[16:19], s55 offen lds
  s_mov_b32 s55, 3932160
  s_add_u32 m0, s57, 6144
  s_nop 0
  buffer_load_dwordx4 v2, s[16:19], s55 offen lds
  s_mov_b32 s55, 4063232
  s_add_u32 m0, s57, 7168
  s_nop 0
  buffer_load_dwordx4 v2, s[16:19], s55 offen lds
  s_waitcnt vmcnt(4)
  ds_read_b64_tr_b16 a[96:97], v8 offset:0
  ds_read_b64_tr_b16 a[98:99], v8 offset:128
  ds_read_b64_tr_b16 a[100:101], v8 offset:2048
  ds_read_b64_tr_b16 a[102:103], v8 offset:2176
  ds_read_b64_tr_b16 a[104:105], v8 offset:32
  ds_read_b64_tr_b16 a[106:107], v8 offset:160
  ds_read_b64_tr_b16 a[108:109], v8 offset:2080
  ds_read_b64_tr_b16 a[110:111], v8 offset:2208
  s_waitcnt lgkmcnt(0)
  s_mov_b32 s55, 0
  s_add_u32 m0, s57, 0
  s_nop 0
  buffer_load_dwordx4 v2, s[20:23], s55 offen lds
  s_mov_b32 s55, 131072
  s_add_u32 m0, s57, 1024
  s_nop 0
  buffer_load_dwordx4 v2, s[20:23], s55 offen lds
  s_mov_b32 s55, 262144
  s_add_u32 m0, s57, 2048
  s_nop 0
  buffer_load_dwordx4 v2, s[20:23], s55 offen lds
  s_mov_b32 s55, 393216
  s_add_u32 m0, s57, 3072
  s_nop 0
  buffer_load_dwordx4 v2, s[20:23], s55 offen lds
  s_waitcnt vmcnt(4)
  ds_read_b64_tr_b16 a[112:113], v8 offset:4096
  ds_read_b64_tr_b16 a[114:115], v8 offset:4224
  ds_read_b64_tr_b16 a[116:117], v8 offset:6144
  ds_read_b64_tr_b16 a[118:119], v8 offset:6272
  ds_read_b64_tr_b16 a[120:121], v8 offset:4128
  ds_read_b64_tr_b16 a[122:123], v8 offset:4256
  ds_read_b64_tr_b16 a[124:125], v8 offset:6176
  ds_read_b64_tr_b16 a[126:127], v8 offset:6304
  s_waitcnt lgkmcnt(0)
  s_mov_b32 s55, 524288
  s_add_u32 m0, s57, 4096
  s_nop 0
  buffer_load_dwordx4 v2, s[20:23], s55 offen lds
  s_mov_b32 s55, 655360
  s_add_u32 m0, s57, 5120
  s_nop 0
  buffer_load_dwordx4 v2, s[20:23], s55 offen lds
  s_mov_b32 s55, 786432
  s_add_u32 m0, s57, 6144
  s_nop 0
  buffer_load_dwordx4 v2, s[20:23], s55 offen lds
  s_mov_b32 s55, 917504
  s_add_u32 m0, s57, 7168
  s_nop 0
  buffer_load_dwordx4 v2, s[20:23], s55 offen lds
  s_waitcnt vmcnt(4)
  ds_read_b64_tr_b16 a[128:129], v8 offset:0
  ds_read_b64_tr_b16 a[130:131], v8 offset:128
  ds_read_b64_tr_b16 a[132:133], v8 offset:2048
  ds_read_b64_tr_b16 a[134:135], v8 offset:2176
  ds_read_b64_tr_b16 a[136:137], v8 offset:32
  ds_read_b64_tr_b16 a[138:139], v8 offset:160
  ds_read_b64_tr_b16 a[140:141], v8 offset:2080
  ds_read_b64_tr_b16 a[142:143], v8 offset:2208
  s_waitcnt lgkmcnt(0)
  s_mov_b32 s55, 1048576
  s_add_u32 m0, s57, 0
  s_nop 0
  buffer_load_dwordx4 v2, s[20:23], s55 offen lds
  s_mov_b32 s55, 1179648
  s_add_u32 m0, s57, 1024
  s_nop 0
  buffer_load_dwordx4 v2, s[20:23], s55 offen lds
  s_mov_b32 s55, 1310720
  s_add_u32 m0, s57, 2048
  s_nop 0
  buffer_load_dwordx4 v2, s[20:23], s55 offen lds
  s_mov_b32 s55, 1441792
  s_add_u32 m0, s57, 3072
  s_nop 0
  buffer_load_dwordx4 v2, s[20:23], s55 offen lds
  s_waitcnt vmcnt(4)
  ds_read_b64_tr_b16 a[144:145], v8 offset:4096
  ds_read_b64_tr_b16 a[146:147], v8 offset:4224
  ds_read_b64_tr_b16 a[148:149], v8 offset:6144
  ds_read_b64_tr_b16 a[150:151], v8 offset:6272
  ds_read_b64_tr_b16 a[152:153], v8 offset:4128
  ds_read_b64_tr_b16 a[154:155], v8 offset:4256
  ds_read_b64_tr_b16 a[156:157], v8 offset:6176
  ds_read_b64_tr_b16 a[158:159], v8 offset:6304
  s_waitcnt lgkmcnt(0)
  s_mov_b32 s55, 1572864
  s_add_u32 m0, s57, 4096
  s_nop 0
  buffer_load_dwordx4 v2, s[20:23], s55 offen lds
  s_mov_b32 s55, 1703936
  s_add_u32 m0, s57, 5120
  s_nop 0
  buffer_load_dwordx4 v2, s[20:23], s55 offen lds
  s_mov_b32 s55, 1835008
  s_add_u32 m0, s57, 6144
  s_nop 0
  buffer_load_dwordx4 v2, s[20:23], s55 offen lds
  s_mov_b32 s55, 1966080
  s_add_u32 m0, s57, 7168
  s_nop 0
  buffer_load_dwordx4 v2, s[20:23], s55 offen lds
  s_waitcnt vmcnt(4)
  ds_read_b64_tr_b16 a[160:161], v8 offset:0
  ds_read_b64_tr_b16 a[162:163], v8 offset:128
  ds_read_b64_tr_b16 a[164:165], v8 offset:2048
  ds_read_b64_tr_b16 a[166:167], v8 offset:2176
  ds_read_b64_tr_b16 a[168:169], v8 offset:32
  ds_read_b64_tr_b16 a[170:171], v8 offset:160
  ds_read_b64_tr_b16 a[172:173], v8 offset:2080
  ds_read_b64_tr_b16 a[174:175], v8 offset:2208
  s_waitcnt lgkmcnt(0)
  s_mov_b32 s55, 2097152
  s_add_u32 m0, s57, 0
  s_nop 0
  buffer_load_dwordx4 v2, s[20:23], s55 offen lds
  s_mov_b32 s55, 2228224
  s_add_u32 m0, s57, 1024
  s_nop 0
  buffer_load_dwordx4 v2, s[20:23], s55 offen lds
  s_mov_b32 s55, 2359296
  s_add_u32 m0, s57, 2048
  s_nop 0
  buffer_load_dwordx4 v2, s[20:23], s55 offen lds
  s_mov_b32 s55, 2490368
  s_add_u32 m0, s57, 3072
  s_nop 0
  buffer_load_dwordx4 v2, s[20:23], s55 offen lds
  s_waitcnt vmcnt(4)
  ds_read_b64_tr_b16 a[176:177], v8 offset:4096
  ds_read_b64_tr_b16 a[178:179], v8 offset:4224
  ds_read_b64_tr_b16 a[180:181], v8 offset:6144
  ds_read_b64_tr_b16 a[182:183], v8 offset:6272
  ds_read_b64_tr_b16 a[184:185], v8 offset:4128
  ds_read_b64_tr_b16 a[186:187], v8 offset:4256
  ds_read_b64_tr_b16 a[188:189], v8 offset:6176
  ds_read_b64_tr_b16 a[190:191], v8 offset:6304
  s_waitcnt lgkmcnt(0)
  s_mov_b32 s55, 2621440
  s_add_u32 m0, s57, 4096
  s_nop 0
  buffer_load_dwordx4 v2, s[20:23], s55 offen lds
  s_mov_b32 s55, 2752512
  s_add_u32 m0, s57, 5120
  s_nop 0
  buffer_load_dwordx4 v2, s[20:23], s55 offen lds
  s_mov_b32 s55, 2883584
  s_add_u32 m0, s57, 6144
  s_nop 0
  buffer_load_dwordx4 v2, s[20:23], s55 offen lds
  s_mov_b32 s55, 3014656
  s_add_u32 m0, s57, 7168
  s_nop 0
  buffer_load_dwordx4 v2, s[20:23], s55 offen lds
  s_waitcnt vmcnt(4)
  ds_read_b64_tr_b16 a[192:193], v8 offset:0
  ds_read_b64_tr_b16 a[194:195], v8 offset:128
  ds_read_b64_tr_b16 a[196:197], v8 offset:2048
  ds_read_b64_tr_b16 a[198:199], v8 offset:2176
  ds_read_b64_tr_b16 a[200:201], v8 offset:32
  ds_read_b64_tr_b16 a[202:203], v8 offset:160
  ds_read_b64_tr_b16 a[204:205], v8 offset:2080
  ds_read_b64_tr_b16 a[206:207], v8 offset:2208
  s_waitcnt lgkmcnt(0)
  s_mov_b32 s55, 3145728
  s_add_u32 m0, s57, 0
  s_nop 0
  buffer_load_dwordx4 v2, s[20:23], s55 offen lds
  s_mov_b32 s55, 3276800
  s_add_u32 m0, s57, 1024
  s_nop 0
  buffer_load_dwordx4 v2, s[20:23], s55 offen lds
  s_mov_b32 s55, 3407872
  s_add_u32 m0, s57, 2048
  s_nop 0
  buffer_load_dwordx4 v2, s[20:23], s55 offen lds
  s_mov_b32 s55, 3538944
  s_add_u32 m0, s57, 3072
  s_nop 0
  buffer_load_dwordx4 v2, s[20:23], s55 offen lds
  s_waitcnt vmcnt(4)
  ds_read_b64_tr_b16 a[208:209], v8 offset:4096
  ds_read_b64_tr_b16 a[210:211], v8 offset:4224
  ds_read_b64_tr_b16 a[212:213], v8 offset:6144
  ds_read_b64_tr_b16 a[214:215], v8 offset:6272
  ds_read_b64_tr_b16 a[216:217], v8 offset:4128
  ds_read_b64_tr_b16 a[218:219], v8 offset:4256
  ds_read_b64_tr_b16 a[220:221], v8 offset:6176
  ds_read_b64_tr_b16 a[222:223], v8 offset:6304
  s_waitcnt lgkmcnt(0)
  s_mov_b32 s55, 3670016
  s_add_u32 m0, s57, 4096
  s_nop 0
  buffer_load_dwordx4 v2, s[20:23], s55 offen lds
  s_mov_b32 s55, 3801088
  s_add_u32 m0, s57, 5120
  s_nop 0
  buffer_load_dwordx4 v2, s[20:23], s55 offen lds
  s_mov_b32 s55, 3932160
  s_add_u32 m0, s57, 6144
  s_nop 0
  buffer_load_dwordx4 v2, s[20:23], s55 offen lds
  s_mov_b32 s55, 4063232
  s_add_u32 m0, s57, 7168
  s_nop 0
  buffer_load_dwordx4 v2, s[20:23], s55 offen lds
  s_waitcnt vmcnt(4)
  ds_read_b64_tr_b16 a[224:225], v8 offset:0
  ds_read_b64_tr_b16 a[226:227], v8 offset:128
  ds_read_b64_tr_b16 a[228:229], v8 offset:2048
  ds_read_b64_tr_b16 a[230:231], v8 offset:2176
  ds_read_b64_tr_b16 a[232:233], v8 offset:32
  ds_read_b64_tr_b16 a[234:235], v8 offset:160
  ds_read_b64_tr_b16 a[236:237], v8 offset:2080
  ds_read_b64_tr_b16 a[238:239], v8 offset:2208
  s_waitcnt lgkmcnt(0)
  s_waitcnt vmcnt(0)
  ds_read_b64_tr_b16 a[240:241], v8 offset:4096
  ds_read_b64_tr_b16 a[242:243], v8 offset:4224
  ds_read_b64_tr_b16 a[244:245], v8 offset:6144
  ds_read_b64_tr_b16 a[246:247], v8 offset:6272
  ds_read_b64_tr_b16 a[248:249], v8 offset:4128
  ds_read_b64_tr_b16 a[250:251], v8 offset:4256
  ds_read_b64_tr_b16 a[252:253], v8 offset:6176
  ds_read_b64_tr_b16 a[254:255], v8 offset:6304
  s_waitcnt lgkmcnt(0)
  s_barrier
  s_lshl_b32 s48, s40, 5
  s_add_u32 s48, s48, 0x40a1018
  v_mov_b32 v7, 1
  v_mov_b32 v6, 0
  s_mov_b64 exec, 1
  buffer_store_dword v7, v6, s[8:11], s48 offen sc1
  s_mov_b64 exec, -1
  s_mov_b32 s55, 64
  s_mov_b32 s56, 256
  v_mul_u32_u24 v6, 4, v0
  s_mov_b32 s54, 1048576
  s_mov_b32 exec_lo, 0x1
  s_mov_b32 exec_hi, 0
L_poll_rdyk_8:
  buffer_load_dword v7, v6, s[32:35], s55 offen sc1
  s_sub_u32 s54, s54, 1
  s_cbranch_scc1 L_fail
  s_waitcnt vmcnt(0)
  v_cmp_gt_u32 vcc, s56, v7
  s_cbranch_vccz L_poll_rdyk_8_ok
  s_sleep 8
  s_branch L_poll_rdyk_8
L_poll_rdyk_8_ok:
  s_mov_b64 exec, -1
  v_and_b32 v7, 15, v0
  v_cmp_gt_u32 vcc, 8, v7
  v_mov_b32 v11, 0xeeee
  v_mov_b32 v14, 0x4444
  v_cndmask_b32 v11, v11, v14, vcc
  v_bfe_u32 v6, v0, 4, 1
  v_lshlrev_b32 v6, 2, v6
  v_and_b32 v7, 7, v0
  v_sub_u32 v7, v7, v6
  v_mov_b32 v15, 0x3f80
  v_mov_b32 v14, 0x3f800000
  v_mov_b32 v12, 0
  v_cmp_eq_u32 vcc, 0, v7
  s_nop 1
  v_cndmask_b32 v12, v12, v15, vcc
  v_cmp_eq_u32 vcc, 1, v7
  s_nop 1
  v_cndmask_b32 v12, v12, v14, vcc
  v_mov_b32 v13, 0
  v_cmp_eq_u32 vcc, 2, v7
  s_nop 1
  v_cndmask_b32 v13, v13, v15, vcc
  v_cmp_eq_u32 vcc, 3, v7
  s_nop 1
  v_cndmask_b32 v13, v13, v14, vcc
  s_lshl_b32 s47, s41, 11
  v_add_u32 v9, s47, v1
  v_mov_b32 v10, v1
  s_add_u32 s45, s47, 0x3000000
  s_lshl_b32 s46, s40, 8
  s_add_u32 s46, s46, s41
  s_lshl_b32 s46, s46, 10
  s_add_u32 s46, s46, 0x3800000
  s_mov_b32 s44, 0
  s_add_u32 s52, s46, 65536
  s_add_u32 s53, s46, 253952
  v_mov_b32 v68, -1
  v_mov_b32 v69, -1
  v_mov_b32 v70, -1
  v_mov_b32 v71, -1
  s_lshl_b32 s48, s40, 5
  s_add_u32 s48, s48, 0x40a1418
  s_mov_b32 m0, s47
  s_nop 0
  buffer_load_dwordx4 v1, s[8:11], s45 offen sc1 lds
  buffer_load_dwordx4 v1, s[8:11], s45 offen offset:1024 sc1 lds
  s_waitcnt vmcnt(0)
L_ks_loop:
  v_mov_b64 v[48:49], 0
  v_mov_b64 v[50:51], 0
  v_mov_b64 v[52:53], 0
  v_mov_b64 v[54:55], 0
  v_mov_b64 v[56:57], 0
  v_mov_b64 v[58:59], 0
  v_mov_b64 v[60:61], 0
  v_mov_b64 v[62:63], 0
  s_mov_b32 s54, 1048576
  s_waitcnt vmcnt(1)
  s_branch L_ks_c
L_ks_r:
  s_sleep 2
  buffer_load_dwordx4 v1, s[8:11], s45 offen sc1 lds
  buffer_load_dwordx4 v1, s[8:11], s45 offen offset:1024 sc1 lds
  s_sub_u32 s54, s54, 1
  s_cbranch_scc1 L_fail
  s_waitcnt vmcnt(2)
L_ks_c:
  ds_read_b128 v[16:19], v9
  ds_read_b128 v[20:23], v9 offset:1024
  s_waitcnt lgkmcnt(0)
  v_max3_u32 v14, v16, v17, v18
  v_max3_u32 v15, v19, v20, v21
  v_max3_u32 v14, v14, v22, v23
  v_max_u32 v14, v14, v15
  v_cmp_eq_u32 vcc, -1, v14
  s_cbranch_vccnz L_ks_r
  s_barrier
  ds_read_b128 v[16:19], v10 offset:0
  ds_read_b128 v[20:23], v10 offset:1024
  ds_read_b128 v[24:27], v10 offset:2048
  s_add_u32 s45, s45, 8192
  s_xor_b32 s47, s47, 8192
  s_mov_b32 m0, s47
  s_waitcnt lgkmcnt(2)
  v_smfmac_f32_16x16x64_bf16 v[48:51], v[16:19], a[0:7], v11
  ds_read_b128 v[28:31], v10 offset:3072
  v_smfmac_f32_16x16x64_bf16 v[52:55], v[16:19], a[8:15], v11
  s_waitcnt lgkmcnt(2)
  v_smfmac_f32_16x16x64_bf16 v[48:51], v[20:23], a[16:23], v11
  ds_read_b128 v[32:35], v10 offset:4096
  v_smfmac_f32_16x16x64_bf16 v[52:55], v[20:23], a[24:31], v11
  s_waitcnt lgkmcnt(2)
  v_smfmac_f32_16x16x64_bf16 v[48:51], v[24:27], a[32:39], v11
  ds_read_b128 v[36:39], v10 offset:5120
  v_smfmac_f32_16x16x64_bf16 v[52:55], v[24:27], a[40:47], v11
  s_waitcnt lgkmcnt(2)
  v_smfmac_f32_16x16x64_bf16 v[48:51], v[28:31], a[48:55], v11
  ds_read_b128 v[40:43], v10 offset:6144
  v_smfmac_f32_16x16x64_bf16 v[52:55], v[28:31], a[56:63], v11
  s_waitcnt lgkmcnt(2)
  v_smfmac_f32_16x16x64_bf16 v[48:51], v[32:35], a[64:71], v11
  ds_read_b128 v[44:47], v10 offset:7168
  v_smfmac_f32_16x16x64_bf16 v[52:55], v[32:35], a[72:79], v11
  s_waitcnt lgkmcnt(2)
  v_smfmac_f32_16x16x64_bf16 v[48:51], v[36:39], a[80:87], v11
  v_smfmac_f32_16x16x64_bf16 v[52:55], v[36:39], a[88:95], v11
  s_waitcnt lgkmcnt(1)
  v_smfmac_f32_16x16x64_bf16 v[48:51], v[40:43], a[96:103], v11
  v_smfmac_f32_16x16x64_bf16 v[52:55], v[40:43], a[104:111], v11
  s_waitcnt lgkmcnt(0)
  v_smfmac_f32_16x16x64_bf16 v[48:51], v[44:47], a[112:119], v11
  v_smfmac_f32_16x16x64_bf16 v[52:55], v[44:47], a[120:127], v11
  v_smfmac_f32_16x16x64_bf16 v[56:59], v[16:19], a[128:135], v11
  v_smfmac_f32_16x16x64_bf16 v[60:63], v[16:19], a[136:143], v11
  v_smfmac_f32_16x16x64_bf16 v[56:59], v[20:23], a[144:151], v11
  buffer_load_dwordx4 v1, s[8:11], s45 offen sc1 lds
  buffer_load_dwordx4 v1, s[8:11], s45 offen offset:1024 sc1 lds
  v_cvt_pk_bf16_f32 v64, v48, v49
  v_cvt_pk_bf16_f32 v65, v50, v51
  v_cvt_pk_bf16_f32 v66, v52, v53
  v_cvt_pk_bf16_f32 v67, v54, v55
  v_smfmac_f32_16x16x64_bf16 v[60:63], v[20:23], a[152:159], v11
  v_mfma_f32_16x16x16_bf16 v[48:51], v[64:65], v[12:13], 0
  v_mfma_f32_16x16x16_bf16 v[52:55], v[66:67], v[12:13], 0
  v_smfmac_f32_16x16x64_bf16 v[56:59], v[24:27], a[160:167], v11
  v_smfmac_f32_16x16x64_bf16 v[60:63], v[24:27], a[168:175], v11
  v_smfmac_f32_16x16x64_bf16 v[56:59], v[28:31], a[176:183], v11
  v_smfmac_f32_16x16x64_bf16 v[60:63], v[28:31], a[184:191], v11
  v_cvt_pk_bf16_f32 v64, v48, v49
  v_cvt_pk_bf16_f32 v65, v50, v51
  v_cvt_pk_bf16_f32 v66, v52, v53
  v_cvt_pk_bf16_f32 v67, v54, v55
  v_smfmac_f32_16x16x64_bf16 v[56:59], v[32:35], a[192:199], v11
  v_smfmac_f32_16x16x64_bf16 v[60:63], v[32:35], a[200:207], v11
  v_mov_b32_dpp v64, v66 quad_perm:[0,1,2,3] row_mask:0xf bank_mask:0xc
  v_mov_b32_dpp v65, v67 quad_perm:[0,1,2,3] row_mask:0xf bank_mask:0xc
  v_min_u32 v64, -2, v64
  v_min_u32 v65, -2, v65
  v_xor_b32 v9, 8192, v9
  v_xor_b32 v10, 8192, v10
  v_smfmac_f32_16x16x64_bf16 v[56:59], v[36:39], a[208:215], v11
  v_smfmac_f32_16x16x64_bf16 v[60:63], v[36:39], a[216:223], v11
  v_smfmac_f32_16x16x64_bf16 v[56:59], v[40:43], a[224:231], v11
  v_smfmac_f32_16x16x64_bf16 v[60:63], v[40:43], a[232:239], v11
  v_smfmac_f32_16x16x64_bf16 v[56:59], v[44:47], a[240:247], v11
  v_smfmac_f32_16x16x64_bf16 v[60:63], v[44:47], a[248:255], v11
  s_nop 7
  v_permlane32_swap_b32 v56, v60
  v_permlane32_swap_b32 v57, v61
  v_permlane32_swap_b32 v58, v62
  v_permlane32_swap_b32 v59, v63
  v_add_f32 v56, v56, v60
  v_add_f32 v57, v57, v61
  v_add_f32 v58, v58, v62
  v_add_f32 v59, v59, v63
  v_cvt_pk_bf16_f32 v66, v56, v57
  v_cvt_pk_bf16_f32 v67, v58, v59
  v_min_u32 v66, -2, v66
  v_min_u32 v67, -2, v67
  buffer_store_dwordx4 v[64:67], v1, s[8:11], s46 offen sc1
  s_add_u32 s46, s46, 4096
  s_add_u32 s44, s44, 1
  s_cmp_gt_u32 s44, 16
  s_cbranch_scc1 L_ks_n
  buffer_store_dwordx4 v[68:71], v1, s[8:11], s52 offen sc1
  s_add_u32 s52, s52, 4096
  s_min_u32 s52, s52, s53
  buffer_store_dwordx4 v[68:71], v1, s[8:11], s52 offen sc1
  s_add_u32 s52, s52, 4096
  s_min_u32 s52, s52, s53
  buffer_store_dwordx4 v[68:71], v1, s[8:11], s52 offen sc1
  s_add_u32 s52, s52, 4096
  s_min_u32 s52, s52, s53
  s_cmp_lt_u32 s44, 16
  s_cbranch_scc1 L_ks_loop
  s_waitcnt vmcnt(0)
  s_barrier
  v_mov_b32 v7, 1
  v_mov_b32 v6, 0
  s_mov_b64 exec, 1
  buffer_store_dword v7, v6, s[8:11], s48 offen sc1
  s_mov_b64 exec, -1
L_ks_n:
  s_cmp_lt_u32 s44, 63
  s_cbranch_scc1 L_ks_loop
  s_branch L_end
L_wk3:
  s_mov_b32 s28, s64
  s_and_b32 s29, s65, 0xffff
  s_mov_b32 s30, 0x200000
  s_mov_b32 s31, 0x00020000
  s_mov_b32 s58, s42
  s_mov_b32 s59, 32
  s_mov_b32 s62, 2
L_pj_top:
  v_lshrrev_b32 v6, 3, v0
  v_lshlrev_b32 v4, 10, v6
  v_lshrrev_b32 v6, 4, v0
  v_and_b32 v7, 7, v0
  v_xor_b32 v7, v7, v6
  v_lshl_add_u32 v4, v7, 4, v4
  s_lshl_b32 s55, s41, 8
  v_add_u32 v4, s55, v4
  v_xor_b32 v12, 0x2040, v4
  v_bfe_u32 v7, v0, 1, 3
  v_xor_b32 v7, v7, v6
  v_and_b32 v6, 15, v0
  v_lshlrev_b32 v5, 7, v6
  v_lshl_add_u32 v5, v7, 4, v5
  v_xor_b32 v13, 64, v5
  v_lshrrev_b32 v6, 2, v0
  v_and_b32 v7, 3, v0
  v_lshlrev_b32 v2, 4, v7
  v_lshl_add_u32 v2, v6, 13, v2
  s_lshl_b32 s55, s40, 8
  s_lshl_b32 s56, s41, 6
  s_add_u32 s55, s55, s56
  v_add_u32 v2, s55, v2
  v_lshrrev_b32 v3, 4, v0
  v_lshlrev_b32 v3, 3, v3
  v_and_b32 v6, 3, v6
  v_add_u32 v3, v3, v6
  v_lshlrev_b32 v3, 6, v3
  v_lshl_add_u32 v3, v7, 3, v3
  v_add_u32 v3, s57, v3
  s_lshl_b32 s55, s40, 2
  s_add_u32 s55, s55, s41
  s_lshl_b32 s48, s55, 3
  s_add_u32 s48, s48, s42
  s_lshl_b32 s48, s48, 4
  s_add_u32 s48, s48, 0x40a4000
  s_cmp_eq_u32 s42, 6
  s_cbranch_scc1 L_pj_b_9
  s_and_b32 s49, s42, 1
  s_lshr_b32 s56, s42, 1
  s_cmp_eq_u32 s56, 0
  s_cselect_b64 s[4:5], s[70:71], s[72:73]
  s_cmp_eq_u32 s56, 2
  s_cselect_b64 s[4:5], s[68:69], s[4:5]
  s_mov_b32 s36, s4
  s_and_b32 s37, s5, 0xffff
  s_mov_b32 s38, 0x400000
  s_mov_b32 s39, 0x00020000
  s_mov_b32 s53, 0x4000
  s_lshl_b32 s55, s40, 8
  s_add_u32 s55, s55, s41
  s_lshl_b32 s46, s55, 12
  s_and_b32 s43, s56, 1
  s_lshl_b32 s52, s43, 11
  s_add_u32 s46, s46, s52
  s_cmp_lg_u32 s56, 2
  s_cbranch_scc1 L_pj_b_9_q
  s_lshl_b32 s46, s55, 11
  s_add_u32 s46, s46, 0x2000000
  s_mov_b32 s53, 0x2000
L_pj_b_9_q:
  s_add_u32 s52, s46, 1024
  s_mov_b32 s5, 8192
  s_branch L_pj_j_10
L_pj_b_9:
  s_and_b32 s49, s40, 1
  s_mul_i32 s49, s49, 6
  s_add_u32 s49, s49, s58
  s_cmp_lt_u32 s49, 4
  s_cselect_b32 s59, 6, 5
  s_mov_b32 s62, 12
  s_lshl_b32 s48, s50, 5
  s_add_u32 s48, s48, s51
  s_lshl_b32 s48, s48, 2
  s_add_u32 s48, s48, s41
  s_lshl_b32 s48, s48, 7
  s_add_u32 s48, s48, 0x40d0000
  s_mov_b32 s36, s80
  s_and_b32 s37, s81, 0xffff
  s_mov_b32 s38, 0x180000
  s_mov_b32 s39, 0x00020000
  s_and_b32 s56, s40, 30
  s_lshl_b32 s46, s56, 18
  s_lshl_b32 s55, s41, 10
  s_add_u32 s46, s46, s55
  s_add_u32 s46, s46, 0x4400000
  s_add_u32 s52, s46, 0x40000
  s_mov_b32 s53, 0x1000
  s_cmp_eq_u32 s41, 2
  s_cselect_b32 s43, 1, 2
  s_cmp_eq_u32 s41, 3
  s_cselect_b32 s43, 3, s43
  v_lshrrev_b32 v6, 2, v0
  v_mul_u32_u24 v2, 3072, v6
  v_and_b32 v7, 3, v0
  v_lshl_add_u32 v2, v7, 4, v2
  s_min_u32 s55, s55, 2048
  s_lshl_b32 s56, s56, 5
  s_add_u32 s55, s55, s56
  v_add_u32 v2, s55, v2
  s_mov_b32 s5, 3072
L_pj_j_10:
  s_lshl_b32 s5, s5, 4
  s_mul_i32 s55, s49, s53
  s_add_u32 s46, s46, s55
  s_add_u32 s52, s52, s55
  s_mul_i32 s53, s53, s62
  s_lshl_b32 s61, s62, 15
  s_lshl_b32 s45, s49, 15
  s_mov_b32 s47, 0x20000
  s_lshl_b32 s55, s41, 12
  s_add_u32 s55, s55, s47
  s_add_u32 m0, s55, 0
  s_add_u32 s56, s45, 0
  buffer_load_dwordx4 v4, s[28:31], s56 offen lds
  s_add_u32 m0, s55, 1024
  s_add_u32 s56, s45, 0
  buffer_load_dwordx4 v12, s[28:31], s56 offen lds
  s_add_u32 m0, s55, 2048
  s_add_u32 s56, s45, 128
  buffer_load_dwordx4 v4, s[28:31], s56 offen lds
  s_add_u32 m0, s55, 3072
  s_add_u32 s56, s45, 128
  buffer_load_dwordx4 v12, s[28:31], s56 offen lds
  s_add_u32 m0, s55, 16384
  s_add_u32 s56, s45, 16384
  buffer_load_dwordx4 v4, s[28:31], s56 offen lds
  s_add_u32 m0, s55, 17408
  s_add_u32 s56, s45, 16384
  buffer_load_dwordx4 v12, s[28:31], s56 offen lds
  s_add_u32 m0, s55, 18432
  s_add_u32 s56, s45, 16512
  buffer_load_dwordx4 v4, s[28:31], s56 offen lds
  s_add_u32 m0, s55, 19456
  s_add_u32 s56, s45, 16512
  buffer_load_dwordx4 v12, s[28:31], s56 offen lds
  s_add_u32 s45, s45, s61
  s_min_u32 s45, s45, 2064384
  s_add_u32 s47, s47, 0x8000
  s_cmp_eq_u32 s47, 0x28000
  s_cselect_b32 s47, 0, s47
  s_cmp_eq_u32 s42, 6
  s_cbranch_scc1 L_pj_nr
  s_waitcnt vmcnt(8)
  s_barrier
  s_cmp_lg_u32 s41, 0
  s_cbranch_scc1 L_ra_13
  v_mov_b32 v6, 64
  v_mov_b32 v7, 1
  s_mov_b64 exec, 1
  buffer_atomic_add v7, v6, s[32:35], 0 offen sc1
  s_mov_b64 exec, -1
L_ra_13:
L_pj_nr:
  s_cmp_lg_u32 s42, 6
  s_cbranch_scc1 L_pj_stg
  s_cmp_eq_u32 s43, 3
  s_cbranch_scc1 L_pj_gate
  s_mov_b32 s55, 64
  s_mov_b32 s56, 256
  v_mul_u32_u24 v6, 4, v0
  s_mov_b32 s54, 1048576
  s_mov_b32 exec_lo, 0x1
  s_mov_b32 exec_hi, 0
L_poll_rdy0_14:
  buffer_load_dword v7, v6, s[32:35], s55 offen sc1
  s_sub_u32 s54, s54, 1
  s_cbranch_scc1 L_fail
  s_waitcnt vmcnt(0)
  v_cmp_gt_u32 vcc, s56, v7
  s_cbranch_vccz L_poll_rdy0_14_ok
  s_sleep 8
  s_branch L_poll_rdy0_14
L_poll_rdy0_14_ok:
  s_mov_b64 exec, -1
  s_and_b32 s4, s40, 30
  s_lshl_b32 s5, s4, 5
  s_add_u32 s5, s5, 0x40a1018
  v_mul_u32_u24 v6, 32, v0
  s_mov_b32 s54, 1048576
  s_mov_b32 exec_lo, 0x3
  s_mov_b32 exec_hi, 0
L_poll_bf_15:
  buffer_load_dword v7, v6, s[8:11], s5 offen sc1
  s_sub_u32 s54, s54, 1
  s_cbranch_scc1 L_fail
  s_waitcnt vmcnt(0)
  v_cmp_gt_u32 vcc, 1, v7
  s_cbranch_vccz L_poll_bf_15_ok
  s_sleep 8
  s_branch L_poll_bf_15
L_poll_bf_15_ok:
  s_mov_b64 exec, -1
  s_lshl_b32 s4, s4, 1
  s_add_u32 s4, s4, s41
  s_lshl_b32 s4, s4, 15
  s_add_u32 s4, s4, 0x3400000
  buffer_load_dwordx4 a[0:3], v1, s[8:11], s4 offen offset:0 sc1
  buffer_load_dwordx4 a[4:7], v1, s[8:11], s4 offen offset:1024 sc1
  buffer_load_dwordx4 a[8:11], v1, s[8:11], s4 offen offset:2048 sc1
  buffer_load_dwordx4 a[12:15], v1, s[8:11], s4 offen offset:3072 sc1
  s_add_u32 s4, s4, 4096
  buffer_load_dwordx4 a[16:19], v1, s[8:11], s4 offen offset:0 sc1
  buffer_load_dwordx4 a[20:23], v1, s[8:11], s4 offen offset:1024 sc1
  buffer_load_dwordx4 a[24:27], v1, s[8:11], s4 offen offset:2048 sc1
  buffer_load_dwordx4 a[28:31], v1, s[8:11], s4 offen offset:3072 sc1
  s_add_u32 s4, s4, 4096
  buffer_load_dwordx4 a[32:35], v1, s[8:11], s4 offen offset:0 sc1
  buffer_load_dwordx4 a[36:39], v1, s[8:11], s4 offen offset:1024 sc1
  buffer_load_dwordx4 a[40:43], v1, s[8:11], s4 offen offset:2048 sc1
  buffer_load_dwordx4 a[44:47], v1, s[8:11], s4 offen offset:3072 sc1
  s_add_u32 s4, s4, 4096
  buffer_load_dwordx4 a[48:51], v1, s[8:11], s4 offen offset:0 sc1
  buffer_load_dwordx4 a[52:55], v1, s[8:11], s4 offen offset:1024 sc1
  buffer_load_dwordx4 a[56:59], v1, s[8:11], s4 offen offset:2048 sc1
  buffer_load_dwordx4 a[60:63], v1, s[8:11], s4 offen offset:3072 sc1
  s_add_u32 s4, s4, 4096
  buffer_load_dwordx4 a[64:67], v1, s[8:11], s4 offen offset:0 sc1
  buffer_load_dwordx4 a[68:71], v1, s[8:11], s4 offen offset:1024 sc1
  buffer_load_dwordx4 a[72:75], v1, s[8:11], s4 offen offset:2048 sc1
  buffer_load_dwordx4 a[76:79], v1, s[8:11], s4 offen offset:3072 sc1
  s_add_u32 s4, s4, 4096
  buffer_load_dwordx4 a[80:83], v1, s[8:11], s4 offen offset:0 sc1
  buffer_load_dwordx4 a[84:87], v1, s[8:11], s4 offen offset:1024 sc1
  buffer_load_dwordx4 a[88:91], v1, s[8:11], s4 offen offset:2048 sc1
  buffer_load_dwordx4 a[92:95], v1, s[8:11], s4 offen offset:3072 sc1
  s_add_u32 s4, s4, 4096
  buffer_load_dwordx4 a[96:99], v1, s[8:11], s4 offen offset:0 sc1
  buffer_load_dwordx4 a[100:103], v1, s[8:11], s4 offen offset:1024 sc1
  buffer_load_dwordx4 a[104:107], v1, s[8:11], s4 offen offset:2048 sc1
  buffer_load_dwordx4 a[108:111], v1, s[8:11], s4 offen offset:3072 sc1
  s_add_u32 s4, s4, 4096
  buffer_load_dwordx4 a[112:115], v1, s[8:11], s4 offen offset:0 sc1
  buffer_load_dwordx4 a[116:119], v1, s[8:11], s4 offen offset:1024 sc1
  buffer_load_dwordx4 a[120:123], v1, s[8:11], s4 offen offset:2048 sc1
  buffer_load_dwordx4 a[124:127], v1, s[8:11], s4 offen offset:3072 sc1
  s_add_u32 s4, s4, 4096
  s_branch L_pj_j2_12
L_pj_stg:
  s_lshl_b32 s4, s41, 15
  v_subrev_u32 v3, s57, v3
  v_add_u32 v3, s4, v3
  s_mov_b32 s55, 0
  s_add_u32 m0, s4, 0
  s_nop 0
  buffer_load_dwordx4 v2, s[36:39], s55 offen lds
  s_add_u32 s55, s55, s5
  s_add_u32 m0, s4, 1024
  s_nop 0
  buffer_load_dwordx4 v2, s[36:39], s55 offen lds
  s_add_u32 s55, s55, s5
  s_add_u32 m0, s4, 2048
  s_nop 0
  buffer_load_dwordx4 v2, s[36:39], s55 offen lds
  s_add_u32 s55, s55, s5
  s_add_u32 m0, s4, 3072
  s_nop 0
  buffer_load_dwordx4 v2, s[36:39], s55 offen lds
  s_add_u32 s55, s55, s5
  s_add_u32 m0, s4, 4096
  s_nop 0
  buffer_load_dwordx4 v2, s[36:39], s55 offen lds
  s_add_u32 s55, s55, s5
  s_add_u32 m0, s4, 5120
  s_nop 0
  buffer_load_dwordx4 v2, s[36:39], s55 offen lds
  s_add_u32 s55, s55, s5
  s_add_u32 m0, s4, 6144
  s_nop 0
  buffer_load_dwordx4 v2, s[36:39], s55 offen lds
  s_add_u32 s55, s55, s5
  s_add_u32 m0, s4, 7168
  s_nop 0
  buffer_load_dwordx4 v2, s[36:39], s55 offen lds
  s_add_u32 s55, s55, s5
  s_add_u32 m0, s4, 8192
  s_nop 0
  buffer_load_dwordx4 v2, s[36:39], s55 offen lds
  s_add_u32 s55, s55, s5
  s_add_u32 m0, s4, 9216
  s_nop 0
  buffer_load_dwordx4 v2, s[36:39], s55 offen lds
  s_add_u32 s55, s55, s5
  s_add_u32 m0, s4, 10240
  s_nop 0
  buffer_load_dwordx4 v2, s[36:39], s55 offen lds
  s_add_u32 s55, s55, s5
  s_add_u32 m0, s4, 11264
  s_nop 0
  buffer_load_dwordx4 v2, s[36:39], s55 offen lds
  s_add_u32 s55, s55, s5
  s_add_u32 m0, s4, 12288
  s_nop 0
  buffer_load_dwordx4 v2, s[36:39], s55 offen lds
  s_add_u32 s55, s55, s5
  s_add_u32 m0, s4, 13312
  s_nop 0
  buffer_load_dwordx4 v2, s[36:39], s55 offen lds
  s_add_u32 s55, s55, s5
  s_add_u32 m0, s4, 14336
  s_nop 0
  buffer_load_dwordx4 v2, s[36:39], s55 offen lds
  s_add_u32 s55, s55, s5
  s_add_u32 m0, s4, 15360
  s_nop 0
  buffer_load_dwordx4 v2, s[36:39], s55 offen lds
  s_add_u32 s55, s55, s5
  s_add_u32 m0, s4, 16384
  s_nop 0
  buffer_load_dwordx4 v2, s[36:39], s55 offen lds
  s_add_u32 s55, s55, s5
  s_add_u32 m0, s4, 17408
  s_nop 0
  buffer_load_dwordx4 v2, s[36:39], s55 offen lds
  s_add_u32 s55, s55, s5
  s_add_u32 m0, s4, 18432
  s_nop 0
  buffer_load_dwordx4 v2, s[36:39], s55 offen lds
  s_add_u32 s55, s55, s5
  s_add_u32 m0, s4, 19456
  s_nop 0
  buffer_load_dwordx4 v2, s[36:39], s55 offen lds
  s_add_u32 s55, s55, s5
  s_add_u32 m0, s4, 20480
  s_nop 0
  buffer_load_dwordx4 v2, s[36:39], s55 offen lds
  s_add_u32 s55, s55, s5
  s_add_u32 m0, s4, 21504
  s_nop 0
  buffer_load_dwordx4 v2, s[36:39], s55 offen lds
  s_add_u32 s55, s55, s5
  s_add_u32 m0, s4, 22528
  s_nop 0
  buffer_load_dwordx4 v2, s[36:39], s55 offen lds
  s_add_u32 s55, s55, s5
  s_add_u32 m0, s4, 23552
  s_nop 0
  buffer_load_dwordx4 v2, s[36:39], s55 offen lds
  s_add_u32 s55, s55, s5
  s_add_u32 m0, s4, 24576
  s_nop 0
  buffer_load_dwordx4 v2, s[36:39], s55 offen lds
  s_add_u32 s55, s55, s5
  s_add_u32 m0, s4, 25600
  s_nop 0
  buffer_load_dwordx4 v2, s[36:39], s55 offen lds
  s_add_u32 s55, s55, s5
  s_add_u32 m0, s4, 26624
  s_nop 0
  buffer_load_dwordx4 v2, s[36:39], s55 offen lds
  s_add_u32 s55, s55, s5
  s_add_u32 m0, s4, 27648
  s_nop 0
  buffer_load_dwordx4 v2, s[36:39], s55 offen lds
  s_add_u32 s55, s55, s5
  s_add_u32 m0, s4, 28672
  s_nop 0
  buffer_load_dwordx4 v2, s[36:39], s55 offen lds
  s_add_u32 s55, s55, s5
  s_add_u32 m0, s4, 29696
  s_nop 0
  buffer_load_dwordx4 v2, s[36:39], s55 offen lds
  s_add_u32 s55, s55, s5
  s_add_u32 m0, s4, 30720
  s_nop 0
  buffer_load_dwordx4 v2, s[36:39], s55 offen lds
  s_add_u32 s55, s55, s5
  s_add_u32 m0, s4, 31744
  s_nop 0
  buffer_load_dwordx4 v2, s[36:39], s55 offen lds
  s_add_u32 s55, s55, s5
  s_waitcnt vmcnt(28)
  ds_read_b64_tr_b16 a[0:1], v3 offset:0
  ds_read_b64_tr_b16 a[2:3], v3 offset:256
  ds_read_b64_tr_b16 a[64:65], v3 offset:32
  ds_read_b64_tr_b16 a[66:67], v3 offset:288
  ds_read_b64_tr_b16 a[4:5], v3 offset:2048
  ds_read_b64_tr_b16 a[6:7], v3 offset:2304
  ds_read_b64_tr_b16 a[68:69], v3 offset:2080
  ds_read_b64_tr_b16 a[70:71], v3 offset:2336
  s_waitcnt vmcnt(24)
  ds_read_b64_tr_b16 a[8:9], v3 offset:4096
  ds_read_b64_tr_b16 a[10:11], v3 offset:4352
  ds_read_b64_tr_b16 a[72:73], v3 offset:4128
  ds_read_b64_tr_b16 a[74:75], v3 offset:4384
  ds_read_b64_tr_b16 a[12:13], v3 offset:6144
  ds_read_b64_tr_b16 a[14:15], v3 offset:6400
  ds_read_b64_tr_b16 a[76:77], v3 offset:6176
  ds_read_b64_tr_b16 a[78:79], v3 offset:6432
  s_waitcnt lgkmcnt(0)
  s_waitcnt vmcnt(20)
  ds_read_b64_tr_b16 a[16:17], v3 offset:8192
  ds_read_b64_tr_b16 a[18:19], v3 offset:8448
  ds_read_b64_tr_b16 a[80:81], v3 offset:8224
  ds_read_b64_tr_b16 a[82:83], v3 offset:8480
  ds_read_b64_tr_b16 a[20:21], v3 offset:10240
  ds_read_b64_tr_b16 a[22:23], v3 offset:10496
  ds_read_b64_tr_b16 a[84:85], v3 offset:10272
  ds_read_b64_tr_b16 a[86:87], v3 offset:10528
  s_waitcnt vmcnt(16)
  ds_read_b64_tr_b16 a[24:25], v3 offset:12288
  ds_read_b64_tr_b16 a[26:27], v3 offset:12544
  ds_read_b64_tr_b16 a[88:89], v3 offset:12320
  ds_read_b64_tr_b16 a[90:91], v3 offset:12576
  ds_read_b64_tr_b16 a[28:29], v3 offset:14336
  ds_read_b64_tr_b16 a[30:31], v3 offset:14592
  ds_read_b64_tr_b16 a[92:93], v3 offset:14368
  ds_read_b64_tr_b16 a[94:95], v3 offset:14624
  s_waitcnt lgkmcnt(0)
  s_waitcnt vmcnt(12)
  ds_read_b64_tr_b16 a[32:33], v3 offset:16384
  ds_read_b64_tr_b16 a[34:35], v3 offset:16640
  ds_read_b64_tr_b16 a[96:97], v3 offset:16416
  ds_read_b64_tr_b16 a[98:99], v3 offset:16672
  ds_read_b64_tr_b16 a[36:37], v3 offset:18432
  ds_read_b64_tr_b16 a[38:39], v3 offset:18688
  ds_read_b64_tr_b16 a[100:101], v3 offset:18464
  ds_read_b64_tr_b16 a[102:103], v3 offset:18720
  s_waitcnt vmcnt(8)
  ds_read_b64_tr_b16 a[40:41], v3 offset:20480
  ds_read_b64_tr_b16 a[42:43], v3 offset:20736
  ds_read_b64_tr_b16 a[104:105], v3 offset:20512
  ds_read_b64_tr_b16 a[106:107], v3 offset:20768
  ds_read_b64_tr_b16 a[44:45], v3 offset:22528
  ds_read_b64_tr_b16 a[46:47], v3 offset:22784
  ds_read_b64_tr_b16 a[108:109], v3 offset:22560
  ds_read_b64_tr_b16 a[110:111], v3 offset:22816
  s_waitcnt lgkmcnt(0)
  s_waitcnt vmcnt(4)
  ds_read_b64_tr_b16 a[48:49], v3 offset:24576
  ds_read_b64_tr_b16 a[50:51], v3 offset:24832
  ds_read_b64_tr_b16 a[112:113], v3 offset:24608
  ds_read_b64_tr_b16 a[114:115], v3 offset:24864
  ds_read_b64_tr_b16 a[52:53], v3 offset:26624
  ds_read_b64_tr_b16 a[54:55], v3 offset:26880
  ds_read_b64_tr_b16 a[116:117], v3 offset:26656
  ds_read_b64_tr_b16 a[118:119], v3 offset:26912
  s_waitcnt vmcnt(0)
  ds_read_b64_tr_b16 a[56:57], v3 offset:28672
  ds_read_b64_tr_b16 a[58:59], v3 offset:28928
  ds_read_b64_tr_b16 a[120:121], v3 offset:28704
  ds_read_b64_tr_b16 a[122:123], v3 offset:28960
  ds_read_b64_tr_b16 a[60:61], v3 offset:30720
  ds_read_b64_tr_b16 a[62:63], v3 offset:30976
  ds_read_b64_tr_b16 a[124:125], v3 offset:30752
  ds_read_b64_tr_b16 a[126:127], v3 offset:31008
  s_waitcnt lgkmcnt(0)
  s_cmp_lg_u32 s43, 3
  s_cbranch_scc1 L_pj_j2_12
L_pj_gate:
  s_mov_b32 s12, s84
  s_and_b32 s13, s85, 0xffff
  s_mov_b32 s14, 0x400
  s_mov_b32 s15, 0x00020000
  v_lshrrev_b32 v2, 4, v0
  v_lshlrev_b32 v2, 4, v2
  buffer_load_dwordx4 a[0:3], v2, s[12:15], 0 offen offset:0
  buffer_load_dwordx4 a[4:7], v2, s[12:15], 0 offen offset:64
  buffer_load_dwordx4 a[8:11], v2, s[12:15], 0 offen offset:128
  buffer_load_dwordx4 a[12:15], v2, s[12:15], 0 offen offset:192
  buffer_load_dwordx4 a[16:19], v2, s[12:15], 0 offen offset:256
  buffer_load_dwordx4 a[20:23], v2, s[12:15], 0 offen offset:320
  buffer_load_dwordx4 a[24:27], v2, s[12:15], 0 offen offset:384
  buffer_load_dwordx4 a[28:31], v2, s[12:15], 0 offen offset:448
  buffer_load_dwordx4 a[32:35], v2, s[12:15], 0 offen offset:512
  buffer_load_dwordx4 a[36:39], v2, s[12:15], 0 offen offset:576
  buffer_load_dwordx4 a[40:43], v2, s[12:15], 0 offen offset:640
  buffer_load_dwordx4 a[44:47], v2, s[12:15], 0 offen offset:704
  buffer_load_dwordx4 a[48:51], v2, s[12:15], 0 offen offset:768
  buffer_load_dwordx4 a[52:55], v2, s[12:15], 0 offen offset:832
  buffer_load_dwordx4 a[56:59], v2, s[12:15], 0 offen offset:896
  buffer_load_dwordx4 a[60:63], v2, s[12:15], 0 offen offset:960
L_pj_j2_12:
  s_waitcnt vmcnt(0)
  s_barrier
  s_mov_b32 s44, 0
  v_mov_b32 v14, v5
  s_mov_b32 s60, 0x20000
  v_add_u32 v5, s60, v14
  v_xor_b32 v13, 64, v5
  s_lshl_b32 s55, s41, 12
  s_add_u32 s55, s55, s47
  s_add_u32 m0, s55, 0
  s_add_u32 s56, s45, 0
  buffer_load_dwordx4 v4, s[28:31], s56 offen lds
  s_add_u32 m0, s55, 1024
  s_add_u32 s56, s45, 0
  buffer_load_dwordx4 v12, s[28:31], s56 offen lds
  s_add_u32 m0, s55, 2048
  s_add_u32 s56, s45, 128
  buffer_load_dwordx4 v4, s[28:31], s56 offen lds
  s_add_u32 m0, s55, 3072
  s_add_u32 s56, s45, 128
  buffer_load_dwordx4 v12, s[28:31], s56 offen lds
  s_add_u32 m0, s55, 16384
  s_add_u32 s56, s45, 16384
  buffer_load_dwordx4 v4, s[28:31], s56 offen lds
  s_add_u32 m0, s55, 17408
  s_add_u32 s56, s45, 16384
  buffer_load_dwordx4 v12, s[28:31], s56 offen lds
  s_add_u32 m0, s55, 18432
  s_add_u32 s56, s45, 16512
  buffer_load_dwordx4 v4, s[28:31], s56 offen lds
  s_add_u32 m0, s55, 19456
  s_add_u32 s56, s45, 16512
  buffer_load_dwordx4 v12, s[28:31], s56 offen lds
  s_add_u32 s45, s45, s61
  s_min_u32 s45, s45, 2064384
  s_add_u32 s47, s47, 0x8000
  s_cmp_eq_u32 s47, 0x28000
  s_cselect_b32 s47, 0, s47
  s_lshl_b32 s55, s41, 12
  s_add_u32 s55, s55, s47
  s_add_u32 m0, s55, 0
  s_add_u32 s56, s45, 0
  buffer_load_dwordx4 v4, s[28:31], s56 offen lds
  s_add_u32 m0, s55, 1024
  s_add_u32 s56, s45, 0
  buffer_load_dwordx4 v12, s[28:31], s56 offen lds
  s_add_u32 m0, s55, 2048
  s_add_u32 s56, s45, 128
  buffer_load_dwordx4 v4, s[28:31], s56 offen lds
  s_add_u32 m0, s55, 3072
  s_add_u32 s56, s45, 128
  buffer_load_dwordx4 v12, s[28:31], s56 offen lds
  s_add_u32 m0, s55, 16384
  s_add_u32 s56, s45, 16384
  buffer_load_dwordx4 v4, s[28:31], s56 offen lds
  s_add_u32 m0, s55, 17408
  s_add_u32 s56, s45, 16384
  buffer_load_dwordx4 v12, s[28:31], s56 offen lds
  s_add_u32 m0, s55, 18432
  s_add_u32 s56, s45, 16512
  buffer_load_dwordx4 v4, s[28:31], s56 offen lds
  s_add_u32 m0, s55, 19456
  s_add_u32 s56, s45, 16512
  buffer_load_dwordx4 v12, s[28:31], s56 offen lds
  s_add_u32 s45, s45, s61
  s_min_u32 s45, s45, 2064384
  s_add_u32 s47, s47, 0x8000
  s_cmp_eq_u32 s47, 0x28000
  s_cselect_b32 s47, 0, s47
  s_cmp_eq_u32 s43, 1
  s_cbranch_scc1 L_pj_td
L_pj_dt:
  s_waitcnt vmcnt(19)
  s_barrier
  s_lshl_b32 s55, s41, 12
  s_add_u32 s55, s55, s47
  ds_read_b128 v[48:51], v5 offset:0
  ds_read_b128 v[52:55], v5 offset:16384
  ds_read_b128 v[56:59], v13 offset:0
  ds_read_b128 v[60:63], v13 offset:16384
  s_waitcnt lgkmcnt(2)
  v_mfma_f32_16x16x32_bf16 v[16:19], a[0:3], v[48:51], 0
  ds_read_b128 v[64:67], v5 offset:2048
  v_mfma_f32_16x16x32_bf16 v[20:23], a[64:67], v[48:51], 0
  ds_read_b128 v[68:71], v5 offset:18432
  v_mfma_f32_16x16x32_bf16 v[24:27], a[0:3], v[52:55], 0
  v_mfma_f32_16x16x32_bf16 v[28:31], a[64:67], v[52:55], 0
  s_waitcnt lgkmcnt(2)
  v_mfma_f32_16x16x32_bf16 v[16:19], a[4:7], v[56:59], v[16:19]
  ds_read_b128 v[48:51], v13 offset:2048
  v_mfma_f32_16x16x32_bf16 v[20:23], a[68:71], v[56:59], v[20:23]
  ds_read_b128 v[52:55], v13 offset:18432
  v_mfma_f32_16x16x32_bf16 v[24:27], a[4:7], v[60:63], v[24:27]
  v_mfma_f32_16x16x32_bf16 v[28:31], a[68:71], v[60:63], v[28:31]
  s_waitcnt lgkmcnt(2)
  v_mfma_f32_16x16x32_bf16 v[16:19], a[8:11], v[64:67], v[16:19]
  ds_read_b128 v[56:59], v5 offset:4096
  v_mfma_f32_16x16x32_bf16 v[20:23], a[72:75], v[64:67], v[20:23]
  ds_read_b128 v[60:63], v5 offset:20480
  v_mfma_f32_16x16x32_bf16 v[24:27], a[8:11], v[68:71], v[24:27]
  v_mfma_f32_16x16x32_bf16 v[28:31], a[72:75], v[68:71], v[28:31]
  s_waitcnt lgkmcnt(2)
  v_mfma_f32_16x16x32_bf16 v[16:19], a[12:15], v[48:51], v[16:19]
  ds_read_b128 v[64:67], v13 offset:4096
  v_mfma_f32_16x16x32_bf16 v[20:23], a[76:79], v[48:51], v[20:23]
  ds_read_b128 v[68:71], v13 offset:20480
  v_mfma_f32_16x16x32_bf16 v[24:27], a[12:15], v[52:55], v[24:27]
  v_mfma_f32_16x16x32_bf16 v[28:31], a[76:79], v[52:55], v[28:31]
  s_waitcnt lgkmcnt(2)
  v_mfma_f32_16x16x32_bf16 v[16:19], a[16:19], v[56:59], v[16:19]
  ds_read_b128 v[48:51], v5 offset:6144
  v_mfma_f32_16x16x32_bf16 v[20:23], a[80:83], v[56:59], v[20:23]
  ds_read_b128 v[52:55], v5 offset:22528
  v_mfma_f32_16x16x32_bf16 v[24:27], a[16:19], v[60:63], v[24:27]
  v_mfma_f32_16x16x32_bf16 v[28:31], a[80:83], v[60:63], v[28:31]
  s_waitcnt lgkmcnt(2)
  v_mfma_f32_16x16x32_bf16 v[16:19], a[20:23], v[64:67], v[16:19]
  ds_read_b128 v[56:59], v13 offset:6144
  v_mfma_f32_16x16x32_bf16 v[20:23], a[84:87], v[64:67], v[20:23]
  ds_read_b128 v[60:63], v13 offset:22528
  v_mfma_f32_16x16x32_bf16 v[24:27], a[20:23], v[68:71], v[24:27]
  v_mfma_f32_16x16x32_bf16 v[28:31], a[84:87], v[68:71], v[28:31]
  s_sub_i32 s56, s44, 1
  s_cmp_gt_u32 s44, 1
  s_cbranch_scc1 L_pjf_16
  s_mov_b32 s56, s44
  s_waitcnt vmcnt(0)
L_pjf_16:
  s_lshl1_add_u32 s56, s56, s49
  s_waitcnt vmcnt(11)
  v_mov_b32 v7, s56
  v_mov_b32 v6, 0
  s_mov_b64 exec, 1
  buffer_store_dword v7, v6, s[8:11], s48 offen sc1
  s_mov_b64 exec, -1
  s_waitcnt lgkmcnt(2)
  v_mfma_f32_16x16x32_bf16 v[16:19], a[24:27], v[48:51], v[16:19]
  ds_read_b128 v[64:67], v5 offset:8192
  v_mfma_f32_16x16x32_bf16 v[20:23], a[88:91], v[48:51], v[20:23]
  ds_read_b128 v[68:71], v5 offset:24576
  v_mfma_f32_16x16x32_bf16 v[24:27], a[24:27], v[52:55], v[24:27]
  v_mfma_f32_16x16x32_bf16 v[28:31], a[88:91], v[52:55], v[28:31]
  s_waitcnt lgkmcnt(2)
  v_mfma_f32_16x16x32_bf16 v[16:19], a[28:31], v[56:59], v[16:19]
  ds_read_b128 v[48:51], v13 offset:8192
  v_mfma_f32_16x16x32_bf16 v[20:23], a[92:95], v[56:59], v[20:23]
  ds_read_b128 v[52:55], v13 offset:24576
  v_mfma_f32_16x16x32_bf16 v[24:27], a[28:31], v[60:63], v[24:27]
  s_add_u32 m0, s55, 0
  s_add_u32 s56, s45, 0
  buffer_load_dwordx4 v4, s[28:31], s56 offen lds
  v_mfma_f32_16x16x32_bf16 v[28:31], a[92:95], v[60:63], v[28:31]
  s_waitcnt lgkmcnt(2)
  v_mfma_f32_16x16x32_bf16 v[16:19], a[32:35], v[64:67], v[16:19]
  ds_read_b128 v[56:59], v5 offset:10240
  v_mfma_f32_16x16x32_bf16 v[20:23], a[96:99], v[64:67], v[20:23]
  ds_read_b128 v[60:63], v5 offset:26624
  v_mfma_f32_16x16x32_bf16 v[24:27], a[32:35], v[68:71], v[24:27]
  s_add_u32 m0, s55, 1024
  s_add_u32 s56, s45, 0
  buffer_load_dwordx4 v12, s[28:31], s56 offen lds
  v_mfma_f32_16x16x32_bf16 v[28:31], a[96:99], v[68:71], v[28:31]
  s_waitcnt lgkmcnt(2)
  v_mfma_f32_16x16x32_bf16 v[16:19], a[36:39], v[48:51], v[16:19]
  ds_read_b128 v[64:67], v13 offset:10240
  v_mfma_f32_16x16x32_bf16 v[20:23], a[100:103], v[48:51], v[20:23]
  ds_read_b128 v[68:71], v13 offset:26624
  v_mfma_f32_16x16x32_bf16 v[24:27], a[36:39], v[52:55], v[24:27]
  s_add_u32 m0, s55, 2048
  s_add_u32 s56, s45, 128
  buffer_load_dwordx4 v4, s[28:31], s56 offen lds
  v_mfma_f32_16x16x32_bf16 v[28:31], a[100:103], v[52:55], v[28:31]
  s_waitcnt lgkmcnt(2)
  v_mfma_f32_16x16x32_bf16 v[16:19], a[40:43], v[56:59], v[16:19]
  ds_read_b128 v[48:51], v5 offset:12288
  v_mfma_f32_16x16x32_bf16 v[20:23], a[104:107], v[56:59], v[20:23]
  ds_read_b128 v[52:55], v5 offset:28672
  v_mfma_f32_16x16x32_bf16 v[24:27], a[40:43], v[60:63], v[24:27]
  s_add_u32 m0, s55, 3072
  s_add_u32 s56, s45, 128
  buffer_load_dwordx4 v12, s[28:31], s56 offen lds
  v_mfma_f32_16x16x32_bf16 v[28:31], a[104:107], v[60:63], v[28:31]
  s_waitcnt lgkmcnt(2)
  v_mfma_f32_16x16x32_bf16 v[16:19], a[44:47], v[64:67], v[16:19]
  ds_read_b128 v[56:59], v13 offset:12288
  v_mfma_f32_16x16x32_bf16 v[20:23], a[108:111], v[64:67], v[20:23]
  ds_read_b128 v[60:63], v13 offset:28672
  v_mfma_f32_16x16x32_bf16 v[24:27], a[44:47], v[68:71], v[24:27]
  s_add_u32 m0, s55, 16384
  s_add_u32 s56, s45, 16384
  buffer_load_dwordx4 v4, s[28:31], s56 offen lds
  v_mfma_f32_16x16x32_bf16 v[28:31], a[108:111], v[68:71], v[28:31]
  s_waitcnt lgkmcnt(2)
  v_mfma_f32_16x16x32_bf16 v[16:19], a[48:51], v[48:51], v[16:19]
  ds_read_b128 v[64:67], v5 offset:14336
  v_mfma_f32_16x16x32_bf16 v[20:23], a[112:115], v[48:51], v[20:23]
  ds_read_b128 v[68:71], v5 offset:30720
  v_mfma_f32_16x16x32_bf16 v[24:27], a[48:51], v[52:55], v[24:27]
  s_add_u32 m0, s55, 17408
  s_add_u32 s56, s45, 16384
  buffer_load_dwordx4 v12, s[28:31], s56 offen lds
  v_mfma_f32_16x16x32_bf16 v[28:31], a[112:115], v[52:55], v[28:31]
  s_waitcnt lgkmcnt(2)
  v_mfma_f32_16x16x32_bf16 v[16:19], a[52:55], v[56:59], v[16:19]
  ds_read_b128 v[48:51], v13 offset:14336
  v_mfma_f32_16x16x32_bf16 v[20:23], a[116:119], v[56:59], v[20:23]
  ds_read_b128 v[52:55], v13 offset:30720
  v_mfma_f32_16x16x32_bf16 v[24:27], a[52:55], v[60:63], v[24:27]
  s_add_u32 m0, s55, 18432
  s_add_u32 s56, s45, 16512
  buffer_load_dwordx4 v4, s[28:31], s56 offen lds
  v_mfma_f32_16x16x32_bf16 v[28:31], a[116:119], v[60:63], v[28:31]
  s_waitcnt lgkmcnt(2)
  v_mfma_f32_16x16x32_bf16 v[16:19], a[56:59], v[64:67], v[16:19]
  v_mfma_f32_16x16x32_bf16 v[20:23], a[120:123], v[64:67], v[20:23]
  v_mfma_f32_16x16x32_bf16 v[24:27], a[56:59], v[68:71], v[24:27]
  s_add_u32 m0, s55, 19456
  s_add_u32 s56, s45, 16512
  buffer_load_dwordx4 v12, s[28:31], s56 offen lds
  v_mfma_f32_16x16x32_bf16 v[28:31], a[120:123], v[68:71], v[28:31]
  s_waitcnt lgkmcnt(0)
  v_mfma_f32_16x16x32_bf16 v[16:19], a[60:63], v[48:51], v[16:19]
  v_mfma_f32_16x16x32_bf16 v[20:23], a[124:127], v[48:51], v[20:23]
  v_mfma_f32_16x16x32_bf16 v[24:27], a[60:63], v[52:55], v[24:27]
  s_add_u32 s45, s45, s61
  s_min_u32 s45, s45, 2064384
  s_add_u32 s47, s47, 0x8000
  s_cmp_eq_u32 s47, 0x28000
  s_cselect_b32 s47, 0, s47
  v_mfma_f32_16x16x32_bf16 v[28:31], a[124:127], v[52:55], v[28:31]
  s_cmp_eq_u32 s43, 2
  s_cbranch_scc1 L_e2_18
  s_cmp_eq_u32 s43, 3
  s_cbranch_scc1 L_e3_19
  v_cvt_pk_bf16_f32 v72, v16, v17
  v_cvt_pk_bf16_f32 v73, v18, v19
  v_cvt_pk_bf16_f32 v74, v20, v21
  v_cvt_pk_bf16_f32 v75, v22, v23
  v_cvt_pk_bf16_f32 v76, v24, v25
  v_cvt_pk_bf16_f32 v77, v26, v27
  v_cvt_pk_bf16_f32 v78, v28, v29
  v_cvt_pk_bf16_f32 v79, v30, v31
L_es_17:
  buffer_store_dwordx4 v[72:75], v1, s[8:11], s46 offen sc1
  buffer_store_dwordx4 v[76:79], v1, s[8:11], s52 offen sc1
  s_add_u32 s46, s46, s53
  s_add_u32 s52, s52, s53
  s_add_u32 s60, s60, 0x8000
  s_cmp_eq_u32 s60, 0x28000
  s_cselect_b32 s60, 0, s60
  v_add_u32 v5, s60, v14
  v_xor_b32 v13, 64, v5
  s_add_u32 s44, s44, 1
  s_cmp_lt_u32 s44, s59
  s_cbranch_scc1 L_pj_dt
  s_branch L_pj_end
L_e2_18:
  s_nop 5
  v_cvt_pk_bf16_f32 v72, v16, v17
  v_cvt_pk_bf16_f32 v73, v18, v19
  v_cvt_pk_bf16_f32 v74, v24, v25
  v_cvt_pk_bf16_f32 v75, v26, v27
  v_cvt_pk_bf16_f32 v76, v20, v21
  v_cvt_pk_bf16_f32 v77, v22, v23
  v_cvt_pk_bf16_f32 v78, v28, v29
  v_cvt_pk_bf16_f32 v79, v30, v31
  s_branch L_es_17
L_e3_19:
  s_nop 5
  v_cvt_pk_bf16_f32 v72, v16, v24
  v_lshlrev_b32 v74, 16, v72
  v_and_b32 v75, 0xffff0000, v72
  v_mul_f32 v74, 0xbfb8aa3b, v74
  v_mul_f32 v75, 0xbfb8aa3b, v75
  v_exp_f32 v74, v74
  v_exp_f32 v75, v75
  v_add_f32 v74, 1.0, v74
  v_add_f32 v75, 1.0, v75
  v_rcp_f32 v74, v74
  v_rcp_f32 v75, v75
  s_nop 0
  v_cvt_pk_bf16_f32 v73, v74, v75
  v_lshlrev_b32 v72, 16, v73
  v_and_b32 v73, 0xffff0000, v73
  v_sub_f32 v74, 1.0, v72
  v_sub_f32 v75, 1.0, v73
  v_cvt_pk_bf16_f32 v75, v74, v75
  v_lshlrev_b32 v74, 16, v75
  v_and_b32 v75, 0xffff0000, v75
  v_mov_b32 v76, v72
  v_mov_b32 v77, v73
  v_mov_b32 v78, v74
  v_mov_b32 v79, v75
  s_branch L_es_17
L_pj_td:
  s_waitcnt vmcnt(19)
  s_barrier
  s_lshl_b32 s55, s41, 12
  s_add_u32 s55, s55, s47
  ds_read_b128 v[48:51], v5 offset:0
  ds_read_b128 v[52:55], v5 offset:16384
  ds_read_b128 v[56:59], v13 offset:0
  ds_read_b128 v[60:63], v13 offset:16384
  s_waitcnt lgkmcnt(2)
  v_mfma_f32_16x16x32_bf16 v[16:19], v[48:51], a[0:3], 0
  ds_read_b128 v[64:67], v5 offset:2048
  v_mfma_f32_16x16x32_bf16 v[24:27], v[48:51], a[64:67], 0
  ds_read_b128 v[68:71], v5 offset:18432
  v_mfma_f32_16x16x32_bf16 v[20:23], v[52:55], a[0:3], 0
  v_mfma_f32_16x16x32_bf16 v[28:31], v[52:55], a[64:67], 0
  s_waitcnt lgkmcnt(2)
  v_mfma_f32_16x16x32_bf16 v[16:19], v[56:59], a[4:7], v[16:19]
  ds_read_b128 v[48:51], v13 offset:2048
  v_mfma_f32_16x16x32_bf16 v[24:27], v[56:59], a[68:71], v[24:27]
  ds_read_b128 v[52:55], v13 offset:18432
  v_mfma_f32_16x16x32_bf16 v[20:23], v[60:63], a[4:7], v[20:23]
  v_mfma_f32_16x16x32_bf16 v[28:31], v[60:63], a[68:71], v[28:31]
  s_waitcnt lgkmcnt(2)
  v_mfma_f32_16x16x32_bf16 v[16:19], v[64:67], a[8:11], v[16:19]
  ds_read_b128 v[56:59], v5 offset:4096
  v_mfma_f32_16x16x32_bf16 v[24:27], v[64:67], a[72:75], v[24:27]
  ds_read_b128 v[60:63], v5 offset:20480
  v_mfma_f32_16x16x32_bf16 v[20:23], v[68:71], a[8:11], v[20:23]
  v_mfma_f32_16x16x32_bf16 v[28:31], v[68:71], a[72:75], v[28:31]
  s_waitcnt lgkmcnt(2)
  v_mfma_f32_16x16x32_bf16 v[16:19], v[48:51], a[12:15], v[16:19]
  ds_read_b128 v[64:67], v13 offset:4096
  v_mfma_f32_16x16x32_bf16 v[24:27], v[48:51], a[76:79], v[24:27]
  ds_read_b128 v[68:71], v13 offset:20480
  v_mfma_f32_16x16x32_bf16 v[20:23], v[52:55], a[12:15], v[20:23]
  v_mfma_f32_16x16x32_bf16 v[28:31], v[52:55], a[76:79], v[28:31]
  s_waitcnt lgkmcnt(2)
  v_mfma_f32_16x16x32_bf16 v[16:19], v[56:59], a[16:19], v[16:19]
  ds_read_b128 v[48:51], v5 offset:6144
  v_mfma_f32_16x16x32_bf16 v[24:27], v[56:59], a[80:83], v[24:27]
  ds_read_b128 v[52:55], v5 offset:22528
  v_mfma_f32_16x16x32_bf16 v[20:23], v[60:63], a[16:19], v[20:23]
  v_mfma_f32_16x16x32_bf16 v[28:31], v[60:63], a[80:83], v[28:31]
  s_waitcnt lgkmcnt(2)
  v_mfma_f32_16x16x32_bf16 v[16:19], v[64:67], a[20:23], v[16:19]
  ds_read_b128 v[56:59], v13 offset:6144
  v_mfma_f32_16x16x32_bf16 v[24:27], v[64:67], a[84:87], v[24:27]
  ds_read_b128 v[60:63], v13 offset:22528
  v_mfma_f32_16x16x32_bf16 v[20:23], v[68:71], a[20:23], v[20:23]
  v_mfma_f32_16x16x32_bf16 v[28:31], v[68:71], a[84:87], v[28:31]
  s_sub_i32 s56, s44, 1
  s_cmp_gt_u32 s44, 1
  s_cbranch_scc1 L_pjf_20
  s_mov_b32 s56, s44
  s_waitcnt vmcnt(0)
L_pjf_20:
  s_lshl1_add_u32 s56, s56, s49
  s_waitcnt vmcnt(11)
  v_mov_b32 v7, s56
  v_mov_b32 v6, 0
  s_mov_b64 exec, 1
  buffer_store_dword v7, v6, s[8:11], s48 offen sc1
  s_mov_b64 exec, -1
  s_waitcnt lgkmcnt(2)
  v_mfma_f32_16x16x32_bf16 v[16:19], v[48:51], a[24:27], v[16:19]
  ds_read_b128 v[64:67], v5 offset:8192
  v_mfma_f32_16x16x32_bf16 v[24:27], v[48:51], a[88:91], v[24:27]
  ds_read_b128 v[68:71], v5 offset:24576
  v_mfma_f32_16x16x32_bf16 v[20:23], v[52:55], a[24:27], v[20:23]
  v_mfma_f32_16x16x32_bf16 v[28:31], v[52:55], a[88:91], v[28:31]
  s_waitcnt lgkmcnt(2)
  v_mfma_f32_16x16x32_bf16 v[16:19], v[56:59], a[28:31], v[16:19]
  ds_read_b128 v[48:51], v13 offset:8192
  v_mfma_f32_16x16x32_bf16 v[24:27], v[56:59], a[92:95], v[24:27]
  ds_read_b128 v[52:55], v13 offset:24576
  v_mfma_f32_16x16x32_bf16 v[20:23], v[60:63], a[28:31], v[20:23]
  s_add_u32 m0, s55, 0
  s_add_u32 s56, s45, 0
  buffer_load_dwordx4 v4, s[28:31], s56 offen lds
  v_mfma_f32_16x16x32_bf16 v[28:31], v[60:63], a[92:95], v[28:31]
  s_waitcnt lgkmcnt(2)
  v_mfma_f32_16x16x32_bf16 v[16:19], v[64:67], a[32:35], v[16:19]
  ds_read_b128 v[56:59], v5 offset:10240
  v_mfma_f32_16x16x32_bf16 v[24:27], v[64:67], a[96:99], v[24:27]
  ds_read_b128 v[60:63], v5 offset:26624
  v_mfma_f32_16x16x32_bf16 v[20:23], v[68:71], a[32:35], v[20:23]
  s_add_u32 m0, s55, 1024
  s_add_u32 s56, s45, 0
  buffer_load_dwordx4 v12, s[28:31], s56 offen lds
  v_mfma_f32_16x16x32_bf16 v[28:31], v[68:71], a[96:99], v[28:31]
  s_waitcnt lgkmcnt(2)
  v_mfma_f32_16x16x32_bf16 v[16:19], v[48:51], a[36:39], v[16:19]
  ds_read_b128 v[64:67], v13 offset:10240
  v_mfma_f32_16x16x32_bf16 v[24:27], v[48:51], a[100:103], v[24:27]
  ds_read_b128 v[68:71], v13 offset:26624
  v_mfma_f32_16x16x32_bf16 v[20:23], v[52:55], a[36:39], v[20:23]
  s_add_u32 m0, s55, 2048
  s_add_u32 s56, s45, 128
  buffer_load_dwordx4 v4, s[28:31], s56 offen lds
  v_mfma_f32_16x16x32_bf16 v[28:31], v[52:55], a[100:103], v[28:31]
  s_waitcnt lgkmcnt(2)
  v_mfma_f32_16x16x32_bf16 v[16:19], v[56:59], a[40:43], v[16:19]
  ds_read_b128 v[48:51], v5 offset:12288
  v_mfma_f32_16x16x32_bf16 v[24:27], v[56:59], a[104:107], v[24:27]
  ds_read_b128 v[52:55], v5 offset:28672
  v_mfma_f32_16x16x32_bf16 v[20:23], v[60:63], a[40:43], v[20:23]
  s_add_u32 m0, s55, 3072
  s_add_u32 s56, s45, 128
  buffer_load_dwordx4 v12, s[28:31], s56 offen lds
  v_mfma_f32_16x16x32_bf16 v[28:31], v[60:63], a[104:107], v[28:31]
  s_waitcnt lgkmcnt(2)
  v_mfma_f32_16x16x32_bf16 v[16:19], v[64:67], a[44:47], v[16:19]
  ds_read_b128 v[56:59], v13 offset:12288
  v_mfma_f32_16x16x32_bf16 v[24:27], v[64:67], a[108:111], v[24:27]
  ds_read_b128 v[60:63], v13 offset:28672
  v_mfma_f32_16x16x32_bf16 v[20:23], v[68:71], a[44:47], v[20:23]
  s_add_u32 m0, s55, 16384
  s_add_u32 s56, s45, 16384
  buffer_load_dwordx4 v4, s[28:31], s56 offen lds
  v_mfma_f32_16x16x32_bf16 v[28:31], v[68:71], a[108:111], v[28:31]
  s_waitcnt lgkmcnt(2)
  v_mfma_f32_16x16x32_bf16 v[16:19], v[48:51], a[48:51], v[16:19]
  ds_read_b128 v[64:67], v5 offset:14336
  v_mfma_f32_16x16x32_bf16 v[24:27], v[48:51], a[112:115], v[24:27]
  ds_read_b128 v[68:71], v5 offset:30720
  v_mfma_f32_16x16x32_bf16 v[20:23], v[52:55], a[48:51], v[20:23]
  s_add_u32 m0, s55, 17408
  s_add_u32 s56, s45, 16384
  buffer_load_dwordx4 v12, s[28:31], s56 offen lds
  v_mfma_f32_16x16x32_bf16 v[28:31], v[52:55], a[112:115], v[28:31]
  s_waitcnt lgkmcnt(2)
  v_mfma_f32_16x16x32_bf16 v[16:19], v[56:59], a[52:55], v[16:19]
  ds_read_b128 v[48:51], v13 offset:14336
  v_mfma_f32_16x16x32_bf16 v[24:27], v[56:59], a[116:119], v[24:27]
  ds_read_b128 v[52:55], v13 offset:30720
  v_mfma_f32_16x16x32_bf16 v[20:23], v[60:63], a[52:55], v[20:23]
  s_add_u32 m0, s55, 18432
  s_add_u32 s56, s45, 16512
  buffer_load_dwordx4 v4, s[28:31], s56 offen lds
  v_mfma_f32_16x16x32_bf16 v[28:31], v[60:63], a[116:119], v[28:31]
  s_waitcnt lgkmcnt(2)
  v_mfma_f32_16x16x32_bf16 v[16:19], v[64:67], a[56:59], v[16:19]
  v_mfma_f32_16x16x32_bf16 v[24:27], v[64:67], a[120:123], v[24:27]
  v_mfma_f32_16x16x32_bf16 v[20:23], v[68:71], a[56:59], v[20:23]
  s_add_u32 m0, s55, 19456
  s_add_u32 s56, s45, 16512
  buffer_load_dwordx4 v12, s[28:31], s56 offen lds
  v_mfma_f32_16x16x32_bf16 v[28:31], v[68:71], a[120:123], v[28:31]
  s_waitcnt lgkmcnt(0)
  v_mfma_f32_16x16x32_bf16 v[16:19], v[48:51], a[60:63], v[16:19]
  v_mfma_f32_16x16x32_bf16 v[24:27], v[48:51], a[124:127], v[24:27]
  v_mfma_f32_16x16x32_bf16 v[20:23], v[52:55], a[60:63], v[20:23]
  s_add_u32 s45, s45, s61
  s_min_u32 s45, s45, 2064384
  s_add_u32 s47, s47, 0x8000
  s_cmp_eq_u32 s47, 0x28000
  s_cselect_b32 s47, 0, s47
  v_mfma_f32_16x16x32_bf16 v[28:31], v[52:55], a[124:127], v[28:31]
  v_cvt_pk_bf16_f32 v72, v16, v17
  v_cvt_pk_bf16_f32 v73, v18, v19
  v_cvt_pk_bf16_f32 v74, v20, v21
  v_cvt_pk_bf16_f32 v75, v22, v23
  v_cvt_pk_bf16_f32 v76, v24, v25
  v_cvt_pk_bf16_f32 v77, v26, v27
  s_nop 1
  v_cvt_pk_bf16_f32 v78, v28, v29
  v_cvt_pk_bf16_f32 v79, v30, v31
L_es_21:
  buffer_store_dwordx4 v[72:75], v1, s[8:11], s46 offen sc1
  buffer_store_dwordx4 v[76:79], v1, s[8:11], s52 offen sc1
  s_add_u32 s46, s46, s53
  s_add_u32 s52, s52, s53
  s_add_u32 s60, s60, 0x8000
  s_cmp_eq_u32 s60, 0x28000
  s_cselect_b32 s60, 0, s60
  v_add_u32 v5, s60, v14
  v_xor_b32 v13, 64, v5
  s_add_u32 s44, s44, 1
  s_cmp_lt_u32 s44, s59
  s_cbranch_scc1 L_pj_td
  s_branch L_pj_end
L_pj_end:
L_pj_end2:
  s_waitcnt vmcnt(0)
  v_mov_b32 v7, 64
  v_mov_b32 v6, 0
  s_mov_b64 exec, 1
  buffer_store_dword v7, v6, s[8:11], s48 offen sc1
  s_mov_b64 exec, -1
  s_barrier
  s_cmp_eq_u32 s42, 6
  s_mov_b32 s42, 6
  s_cbranch_scc0 L_pj_top
  s_mov_b32 s42, s58
  s_lshl_b32 s48, s40, 3
  s_add_u32 s48, s48, s42
  s_lshl_b32 s48, s48, 2
  s_add_u32 s48, s48, 0x40a1000
  v_mov_b32 v7, 1
  v_mov_b32 v6, 0
  s_mov_b64 exec, 1
  buffer_store_dword v7, v6, s[8:11], s48 offen sc1
  s_mov_b64 exec, -1
  s_cmp_lt_u32 s42, 4
  s_cselect_b32 s43, 11, 10
  s_mov_b32 s55, 64
  s_mov_b32 s56, 256
  v_mul_u32_u24 v6, 4, v0
  s_mov_b32 s54, 1048576
  s_mov_b32 exec_lo, 0x1
  s_mov_b32 exec_hi, 0
L_poll_rdy_22:
  buffer_load_dword v7, v6, s[32:35], s55 offen sc1
  s_sub_u32 s54, s54, 1
  s_cbranch_scc1 L_fail
  s_waitcnt vmcnt(0)
  v_cmp_gt_u32 vcc, s56, v7
  s_cbranch_vccz L_poll_rdy_22_ok
  s_sleep 8
  s_branch L_poll_rdy_22
L_poll_rdy_22_ok:
  s_mov_b64 exec, -1
  s_mov_b32 s36, s82
  s_and_b32 s37, s83, 0xffff
  s_mov_b32 s38, 0x80000
  s_mov_b32 s39, 0x00020000
  s_barrier
  s_mul_i32 s63, s41, 40960
  v_mov_b32 v8, -1
  v_mov_b32 v9, -1
  v_mov_b32 v10, -1
  v_mov_b32 v11, -1
  s_lshl_b32 s55, s50, 20
  s_lshl_b32 s56, s51, 14
  s_add_u32 s55, s55, s56
  s_lshl_b32 s56, s41, 12
  s_add_u32 s55, s55, s56
  s_add_u32 s55, s55, 0x5000000
  buffer_store_dwordx4 v[8:11], v1, s[8:11], s55 offen offset:0
  buffer_store_dwordx4 v[8:11], v1, s[8:11], s55 offen offset:1024
  buffer_store_dwordx4 v[8:11], v1, s[8:11], s55 offen offset:2048
  buffer_store_dwordx4 v[8:11], v1, s[8:11], s55 offen offset:3072
  s_add_u32 s55, s55, 0x80000
  buffer_store_dwordx4 v[8:11], v1, s[8:11], s55 offen offset:0
  buffer_store_dwordx4 v[8:11], v1, s[8:11], s55 offen offset:1024
  buffer_store_dwordx4 v[8:11], v1, s[8:11], s55 offen offset:2048
  buffer_store_dwordx4 v[8:11], v1, s[8:11], s55 offen offset:3072
  s_add_u32 s55, s55, 0x80000
  v_lshrrev_b32 v6, 2, v0
  v_and_b32 v7, 3, v0
  v_mul_u32_u24 v3, 1056, v6
  v_lshl_add_u32 v3, v7, 3, v3
  s_lshl_b32 s56, s41, 8
  v_add_u32 v3, s56, v3
  v_add_u32 v5, s63, v1
  v_lshrrev_b32 v6, 1, v0
  v_lshlrev_b32 v244, 10, v6
  v_and_b32 v7, 1, v0
  v_lshl_add_u32 v244, v7, 4, v244
  s_lshl_b32 s55, s41, 17
  s_lshl_b32 s56, s51, 5
  s_add_u32 s55, s55, s56
  v_add_u32 v244, s55, v244
  s_mov_b32 s55, 0
  s_add_u32 m0, s63, 36864
  s_nop 0
  buffer_load_dwordx4 v244, s[36:39], s55 offen lds
  s_mov_b32 s55, 32768
  s_add_u32 m0, s63, 37888
  s_nop 0
  buffer_load_dwordx4 v244, s[36:39], s55 offen lds
  s_mov_b32 s55, 65536
  s_add_u32 m0, s63, 38912
  s_nop 0
  buffer_load_dwordx4 v244, s[36:39], s55 offen lds
  s_mov_b32 s55, 98304
  s_add_u32 m0, s63, 39936
  s_nop 0
  buffer_load_dwordx4 v244, s[36:39], s55 offen lds
  s_lshl_b32 s58, s51, 2
  s_add_u32 s58, s58, s41
  s_lshl_b32 s58, s58, 15
  s_mov_b32 s16, s74
  s_and_b32 s17, s75, 0xffff
  s_mov_b32 s18, 0x400000
  s_mov_b32 s19, 0x00020000
  s_mov_b32 s47, 1056
  s_mov_b32 m0, s63
  s_and_b32 s52, s40, 30
  s_lshl_b32 s52, s52, 5
  s_add_u32 s52, s52, 0x40a1000
  v_mul_u32_u24 v6, 4, v0
  s_mov_b32 s54, 1048576
  s_mov_b32 exec_lo, 0x3f3f
  s_mov_b32 exec_hi, 0
L_poll_d2_23:
  buffer_load_dword v7, v6, s[8:11], s52 offen sc1
  s_sub_u32 s54, s54, 1
  s_cbranch_scc1 L_fail
  s_waitcnt vmcnt(0)
  v_cmp_gt_u32 vcc, 1, v7
  s_cbranch_vccz L_poll_d2_23_ok
  s_sleep 8
  s_branch L_poll_d2_23
L_poll_d2_23_ok:
  s_mov_b64 exec, -1
  v_lshrrev_b32 v6, 4, v0
  v_lshlrev_b32 v6, 2, v6
  v_and_b32 v7, 15, v0
  v_sub_u32 v7, v7, v6
  v_cmp_le_i32 s[92:93], 0, v7
  v_cmp_le_i32 s[94:95], 1, v7
  v_cmp_le_i32 s[96:97], 2, v7
  v_cmp_le_i32 s[98:99], 3, v7
  v_mov_b32 v228, 0xff800000
  s_mov_b32 s44, s41
  s_mov_b32 s61, 0
L_ba_loop:
  s_cmp_ge_u32 s44, s43
  s_cbranch_scc1 L_ba_nl
  s_mul_i32 s49, s44, 6
  s_add_u32 s49, s49, s42
  s_lshl_b32 s52, s40, 18
  s_add_u32 s52, s52, 0x4400000
  s_lshl_b32 s55, s49, 12
  s_add_u32 s55, s55, s52
  buffer_load_dwordx4 v[8:11], v1, s[8:11], s55 offen sc1
  s_sub_i32 s55, s49, 8
  s_max_i32 s55, s55, 0
  s_lshl_b32 s55, s55, 12
  s_add_u32 s55, s55, s52
  buffer_load_dwordx4 v[12:15], v1, s[8:11], s55 offen offset:1024 sc1
  buffer_load_dwordx4 v[48:51], v1, s[8:11], s55 offen offset:2048 sc1
  s_sub_i32 s55, s49, 7
  s_max_i32 s55, s55, 0
  s_lshl_b32 s55, s55, 12
  s_add_u32 s55, s55, s52
  buffer_load_dwordx4 v[16:19], v1, s[8:11], s55 offen offset:1024 sc1
  buffer_load_dwordx4 v[52:55], v1, s[8:11], s55 offen offset:2048 sc1
  s_sub_i32 s55, s49, 6
  s_max_i32 s55, s55, 0
  s_lshl_b32 s55, s55, 12
  s_add_u32 s55, s55, s52
  buffer_load_dwordx4 v[20:23], v1, s[8:11], s55 offen offset:1024 sc1
  buffer_load_dwordx4 v[56:59], v1, s[8:11], s55 offen offset:2048 sc1
  s_sub_i32 s55, s49, 5
  s_max_i32 s55, s55, 0
  s_lshl_b32 s55, s55, 12
  s_add_u32 s55, s55, s52
  buffer_load_dwordx4 v[24:27], v1, s[8:11], s55 offen offset:1024 sc1
  buffer_load_dwordx4 v[60:63], v1, s[8:11], s55 offen offset:2048 sc1
  s_sub_i32 s55, s49, 4
  s_max_i32 s55, s55, 0
  s_lshl_b32 s55, s55, 12
  s_add_u32 s55, s55, s52
  buffer_load_dwordx4 v[28:31], v1, s[8:11], s55 offen offset:1024 sc1
  buffer_load_dwordx4 v[64:67], v1, s[8:11], s55 offen offset:2048 sc1
  s_sub_i32 s55, s49, 3
  s_max_i32 s55, s55, 0
  s_lshl_b32 s55, s55, 12
  s_add_u32 s55, s55, s52
  buffer_load_dwordx4 v[32:35], v1, s[8:11], s55 offen offset:1024 sc1
  buffer_load_dwordx4 v[68:71], v1, s[8:11], s55 offen offset:2048 sc1
  s_sub_i32 s55, s49, 2
  s_max_i32 s55, s55, 0
  s_lshl_b32 s55, s55, 12
  s_add_u32 s55, s55, s52
  buffer_load_dwordx4 v[36:39], v1, s[8:11], s55 offen offset:1024 sc1
  buffer_load_dwordx4 v[72:75], v1, s[8:11], s55 offen offset:2048 sc1
  s_sub_i32 s55, s49, 1
  s_max_i32 s55, s55, 0
  s_lshl_b32 s55, s55, 12
  s_add_u32 s55, s55, s52
  buffer_load_dwordx4 v[40:43], v1, s[8:11], s55 offen offset:1024 sc1
  buffer_load_dwordx4 v[76:79], v1, s[8:11], s55 offen offset:2048 sc1
  s_sub_i32 s55, s49, 0
  s_max_i32 s55, s55, 0
  s_lshl_b32 s55, s55, 12
  s_add_u32 s55, s55, s52
  buffer_load_dwordx4 v[44:47], v1, s[8:11], s55 offen offset:1024 sc1
  buffer_load_dwordx4 v[80:83], v1, s[8:11], s55 offen offset:2048 sc1
L_ba_nl:
L_ba_pre_j:
  s_cmp_ge_u32 s44, s43
  s_cbranch_scc1 L_ba_only
  s_waitcnt vmcnt(17)
  v_mfma_f32_16x16x16_bf16 v[84:87], v[12:13], v[8:9], 0
  v_mfma_f32_16x16x16_bf16 v[92:95], v[14:15], v[8:9], 0
  v_mfma_f32_16x16x16_bf16 v[96:99], v[14:15], v[10:11], 0
  s_waitcnt vmcnt(15)
  v_mfma_f32_16x16x16_bf16 v[100:103], v[16:17], v[8:9], 0
  v_mfma_f32_16x16x16_bf16 v[104:107], v[16:17], v[10:11], 0
  v_mfma_f32_16x16x16_bf16 v[108:111], v[18:19], v[8:9], 0
  v_mfma_f32_16x16x16_bf16 v[112:115], v[18:19], v[10:11], 0
  s_waitcnt vmcnt(13)
  v_mfma_f32_16x16x16_bf16 v[116:119], v[20:21], v[8:9], 0
  v_mfma_f32_16x16x16_bf16 v[120:123], v[20:21], v[10:11], 0
  v_mfma_f32_16x16x16_bf16 v[124:127], v[22:23], v[8:9], 0
  v_mfma_f32_16x16x16_bf16 v[128:131], v[22:23], v[10:11], 0
  s_waitcnt vmcnt(11)
  v_mfma_f32_16x16x16_bf16 v[132:135], v[24:25], v[8:9], 0
  v_mfma_f32_16x16x16_bf16 v[136:139], v[24:25], v[10:11], 0
  v_mfma_f32_16x16x16_bf16 v[140:143], v[26:27], v[8:9], 0
  v_mfma_f32_16x16x16_bf16 v[144:147], v[26:27], v[10:11], 0
  s_waitcnt vmcnt(9)
  v_mfma_f32_16x16x16_bf16 v[148:151], v[28:29], v[8:9], 0
  v_mfma_f32_16x16x16_bf16 v[152:155], v[28:29], v[10:11], 0
  v_mfma_f32_16x16x16_bf16 v[156:159], v[30:31], v[8:9], 0
  v_mfma_f32_16x16x16_bf16 v[160:163], v[30:31], v[10:11], 0
  s_waitcnt vmcnt(7)
  v_mfma_f32_16x16x16_bf16 v[164:167], v[32:33], v[8:9], 0
  v_mfma_f32_16x16x16_bf16 v[168:171], v[32:33], v[10:11], 0
  v_mfma_f32_16x16x16_bf16 v[172:175], v[34:35], v[8:9], 0
  v_mfma_f32_16x16x16_bf16 v[176:179], v[34:35], v[10:11], 0
  s_waitcnt vmcnt(5)
  v_mfma_f32_16x16x16_bf16 v[180:183], v[36:37], v[8:9], 0
  v_mfma_f32_16x16x16_bf16 v[184:187], v[36:37], v[10:11], 0
  v_mfma_f32_16x16x16_bf16 v[188:191], v[38:39], v[8:9], 0
  v_mfma_f32_16x16x16_bf16 v[192:195], v[38:39], v[10:11], 0
  s_waitcnt vmcnt(3)
  v_mfma_f32_16x16x16_bf16 v[196:199], v[40:41], v[8:9], 0
  v_mfma_f32_16x16x16_bf16 v[200:203], v[40:41], v[10:11], 0
  v_mfma_f32_16x16x16_bf16 v[204:207], v[42:43], v[8:9], 0
  v_mfma_f32_16x16x16_bf16 v[208:211], v[42:43], v[10:11], 0
  s_waitcnt vmcnt(1)
  v_mfma_f32_16x16x16_bf16 v[212:215], v[44:45], v[8:9], 0
  v_mfma_f32_16x16x16_bf16 v[216:219], v[44:45], v[10:11], 0
  v_mfma_f32_16x16x16_bf16 v[224:227], v[46:47], v[10:11], 0
  s_nop 8
  v_cndmask_b32 v212, v228, v212, s[92:93]
  v_cndmask_b32 v84, v84, v228, s[92:93]
  v_cndmask_b32 v213, v228, v213, s[94:95]
  v_cndmask_b32 v85, v85, v228, s[94:95]
  v_cndmask_b32 v214, v228, v214, s[96:97]
  v_cndmask_b32 v86, v86, v228, s[96:97]
  v_cndmask_b32 v215, v228, v215, s[98:99]
  v_cndmask_b32 v87, v87, v228, s[98:99]
  v_cndmask_b32 v224, v228, v224, s[92:93]
  v_cndmask_b32 v96, v96, v228, s[92:93]
  v_cndmask_b32 v225, v228, v225, s[94:95]
  v_cndmask_b32 v97, v97, v228, s[94:95]
  v_cndmask_b32 v226, v228, v226, s[96:97]
  v_cndmask_b32 v98, v98, v228, s[96:97]
  v_cndmask_b32 v227, v228, v227, s[98:99]
  v_cndmask_b32 v99, v99, v228, s[98:99]
  s_cmp_ge_u32 s49, 8
  s_cbranch_scc1 L_ba_valid_24
  v_mov_b32 v84, v228
  v_mov_b32 v85, v228
  v_mov_b32 v86, v228
  v_mov_b32 v87, v228
  v_mov_b32 v88, v228
  v_mov_b32 v89, v228
  v_mov_b32 v90, v228
  v_mov_b32 v91, v228
  v_mov_b32 v92, v228
  v_mov_b32 v93, v228
  v_mov_b32 v94, v228
  v_mov_b32 v95, v228
  v_mov_b32 v96, v228
  v_mov_b32 v97, v228
  v_mov_b32 v98, v228
  v_mov_b32 v99, v228
  s_cmp_ge_u32 s49, 7
  s_cbranch_scc1 L_ba_valid_24
  v_mov_b32 v100, v228
  v_mov_b32 v101, v228
  v_mov_b32 v102, v228
  v_mov_b32 v103, v228
  v_mov_b32 v104, v228
  v_mov_b32 v105, v228
  v_mov_b32 v106, v228
  v_mov_b32 v107, v228
  v_mov_b32 v108, v228
  v_mov_b32 v109, v228
  v_mov_b32 v110, v228
  v_mov_b32 v111, v228
  v_mov_b32 v112, v228
  v_mov_b32 v113, v228
  v_mov_b32 v114, v228
  v_mov_b32 v115, v228
  s_cmp_ge_u32 s49, 6
  s_cbranch_scc1 L_ba_valid_24
  v_mov_b32 v116, v228
  v_mov_b32 v117, v228
  v_mov_b32 v118, v228
  v_mov_b32 v119, v228
  v_mov_b32 v120, v228
  v_mov_b32 v121, v228
  v_mov_b32 v122, v228
  v_mov_b32 v123, v228
  v_mov_b32 v124, v228
  v_mov_b32 v125, v228
  v_mov_b32 v126, v228
  v_mov_b32 v127, v228
  v_mov_b32 v128, v228
  v_mov_b32 v129, v228
  v_mov_b32 v130, v228
  v_mov_b32 v131, v228
  s_cmp_ge_u32 s49, 5
  s_cbranch_scc1 L_ba_valid_24
  v_mov_b32 v132, v228
  v_mov_b32 v133, v228
  v_mov_b32 v134, v228
  v_mov_b32 v135, v228
  v_mov_b32 v136, v228
  v_mov_b32 v137, v228
  v_mov_b32 v138, v228
  v_mov_b32 v139, v228
  v_mov_b32 v140, v228
  v_mov_b32 v141, v228
  v_mov_b32 v142, v228
  v_mov_b32 v143, v228
  v_mov_b32 v144, v228
  v_mov_b32 v145, v228
  v_mov_b32 v146, v228
  v_mov_b32 v147, v228
  s_cmp_ge_u32 s49, 4
  s_cbranch_scc1 L_ba_valid_24
  v_mov_b32 v148, v228
  v_mov_b32 v149, v228
  v_mov_b32 v150, v228
  v_mov_b32 v151, v228
  v_mov_b32 v152, v228
  v_mov_b32 v153, v228
  v_mov_b32 v154, v228
  v_mov_b32 v155, v228
  v_mov_b32 v156, v228
  v_mov_b32 v157, v228
  v_mov_b32 v158, v228
  v_mov_b32 v159, v228
  v_mov_b32 v160, v228
  v_mov_b32 v161, v228
  v_mov_b32 v162, v228
  v_mov_b32 v163, v228
  s_cmp_ge_u32 s49, 3
  s_cbranch_scc1 L_ba_valid_24
  v_mov_b32 v164, v228
  v_mov_b32 v165, v228
  v_mov_b32 v166, v228
  v_mov_b32 v167, v228
  v_mov_b32 v168, v228
  v_mov_b32 v169, v228
  v_mov_b32 v170, v228
  v_mov_b32 v171, v228
  v_mov_b32 v172, v228
  v_mov_b32 v173, v228
  v_mov_b32 v174, v228
  v_mov_b32 v175, v228
  v_mov_b32 v176, v228
  v_mov_b32 v177, v228
  v_mov_b32 v178, v228
  v_mov_b32 v179, v228
  s_cmp_ge_u32 s49, 2
  s_cbranch_scc1 L_ba_valid_24
  v_mov_b32 v180, v228
  v_mov_b32 v181, v228
  v_mov_b32 v182, v228
  v_mov_b32 v183, v228
  v_mov_b32 v184, v228
  v_mov_b32 v185, v228
  v_mov_b32 v186, v228
  v_mov_b32 v187, v228
  v_mov_b32 v188, v228
  v_mov_b32 v189, v228
  v_mov_b32 v190, v228
  v_mov_b32 v191, v228
  v_mov_b32 v192, v228
  v_mov_b32 v193, v228
  v_mov_b32 v194, v228
  v_mov_b32 v195, v228
  s_cmp_ge_u32 s49, 1
  s_cbranch_scc1 L_ba_valid_24
  v_mov_b32 v196, v228
  v_mov_b32 v197, v228
  v_mov_b32 v198, v228
  v_mov_b32 v199, v228
  v_mov_b32 v200, v228
  v_mov_b32 v201, v228
  v_mov_b32 v202, v228
  v_mov_b32 v203, v228
  v_mov_b32 v204, v228
  v_mov_b32 v205, v228
  v_mov_b32 v206, v228
  v_mov_b32 v207, v228
  v_mov_b32 v208, v228
  v_mov_b32 v209, v228
  v_mov_b32 v210, v228
  v_mov_b32 v211, v228
L_ba_valid_24:
  s_mov_b32 s53, 0x3eb8aa3b
  s_mov_b32 s52, 0x3eb8aa3b
  v_cvt_pk_bf16_f32 v85, v84, v85
  buffer_load_dwordx4 v1, s[16:19], s58 offen lds
  s_add_u32 m0, m0, s47
  s_add_u32 s58, s58, 1024
  s_min_u32 s58, s58, 0x3ffc00
  v_lshlrev_b32 v84, 16, v85
  v_and_b32 v85, 0xffff0000, v85
  v_cvt_pk_bf16_f32 v87, v86, v87
  v_lshlrev_b32 v86, 16, v87
  v_and_b32 v87, 0xffff0000, v87
  v_cvt_pk_bf16_f32 v93, v92, v93
  v_lshlrev_b32 v92, 16, v93
  v_and_b32 v93, 0xffff0000, v93
  v_cvt_pk_bf16_f32 v95, v94, v95
  v_lshlrev_b32 v94, 16, v95
  v_and_b32 v95, 0xffff0000, v95
  v_cvt_pk_bf16_f32 v101, v100, v101
  v_lshlrev_b32 v100, 16, v101
  v_and_b32 v101, 0xffff0000, v101
  v_cvt_pk_bf16_f32 v103, v102, v103
  v_lshlrev_b32 v102, 16, v103
  v_and_b32 v103, 0xffff0000, v103
  v_cvt_pk_bf16_f32 v109, v108, v109
  v_lshlrev_b32 v108, 16, v109
  v_and_b32 v109, 0xffff0000, v109
  v_cvt_pk_bf16_f32 v111, v110, v111
  v_lshlrev_b32 v110, 16, v111
  v_and_b32 v111, 0xffff0000, v111
  v_cvt_pk_bf16_f32 v117, v116, v117
  v_lshlrev_b32 v116, 16, v117
  v_and_b32 v117, 0xffff0000, v117
  v_cvt_pk_bf16_f32 v119, v118, v119
  v_lshlrev_b32 v118, 16, v119
  v_and_b32 v119, 0xffff0000, v119
  v_cvt_pk_bf16_f32 v125, v124, v125
  v_lshlrev_b32 v124, 16, v125
  v_and_b32 v125, 0xffff0000, v125
  v_cvt_pk_bf16_f32 v127, v126, v127
  v_lshlrev_b32 v126, 16, v127
  v_and_b32 v127, 0xffff0000, v127
  v_cvt_pk_bf16_f32 v133, v132, v133
  v_lshlrev_b32 v132, 16, v133
  v_and_b32 v133, 0xffff0000, v133
  v_cvt_pk_bf16_f32 v135, v134, v135
  v_lshlrev_b32 v134, 16, v135
  v_and_b32 v135, 0xffff0000, v135
  v_cvt_pk_bf16_f32 v141, v140, v141
  v_lshlrev_b32 v140, 16, v141
  v_and_b32 v141, 0xffff0000, v141
  v_cvt_pk_bf16_f32 v143, v142, v143
  v_lshlrev_b32 v142, 16, v143
  v_and_b32 v143, 0xffff0000, v143
  v_cvt_pk_bf16_f32 v149, v148, v149
  v_lshlrev_b32 v148, 16, v149
  v_and_b32 v149, 0xffff0000, v149
  v_cvt_pk_bf16_f32 v151, v150, v151
  v_lshlrev_b32 v150, 16, v151
  v_and_b32 v151, 0xffff0000, v151
  v_cvt_pk_bf16_f32 v157, v156, v157
  v_lshlrev_b32 v156, 16, v157
  v_and_b32 v157, 0xffff0000, v157
  buffer_load_dwordx4 v1, s[16:19], s58 offen lds
  s_add_u32 m0, m0, s47
  s_add_u32 s58, s58, 1024
  s_min_u32 s58, s58, 0x3ffc00
  v_cvt_pk_bf16_f32 v159, v158, v159
  v_lshlrev_b32 v158, 16, v159
  v_and_b32 v159, 0xffff0000, v159
  v_cvt_pk_bf16_f32 v165, v164, v165
  v_lshlrev_b32 v164, 16, v165
  v_and_b32 v165, 0xffff0000, v165
  v_cvt_pk_bf16_f32 v167, v166, v167
  v_lshlrev_b32 v166, 16, v167
  v_and_b32 v167, 0xffff0000, v167
  v_cvt_pk_bf16_f32 v173, v172, v173
  v_lshlrev_b32 v172, 16, v173
  v_and_b32 v173, 0xffff0000, v173
  v_cvt_pk_bf16_f32 v175, v174, v175
  v_lshlrev_b32 v174, 16, v175
  v_and_b32 v175, 0xffff0000, v175
  v_cvt_pk_bf16_f32 v181, v180, v181
  v_lshlrev_b32 v180, 16, v181
  v_and_b32 v181, 0xffff0000, v181
  v_cvt_pk_bf16_f32 v183, v182, v183
  v_lshlrev_b32 v182, 16, v183
  v_and_b32 v183, 0xffff0000, v183
  v_cvt_pk_bf16_f32 v189, v188, v189
  v_lshlrev_b32 v188, 16, v189
  v_and_b32 v189, 0xffff0000, v189
  v_cvt_pk_bf16_f32 v191, v190, v191
  v_lshlrev_b32 v190, 16, v191
  v_and_b32 v191, 0xffff0000, v191
  v_cvt_pk_bf16_f32 v197, v196, v197
  v_lshlrev_b32 v196, 16, v197
  v_and_b32 v197, 0xffff0000, v197
  v_cvt_pk_bf16_f32 v199, v198, v199
  v_lshlrev_b32 v198, 16, v199
  v_and_b32 v199, 0xffff0000, v199
  v_cvt_pk_bf16_f32 v205, v204, v205
  v_lshlrev_b32 v204, 16, v205
  v_and_b32 v205, 0xffff0000, v205
  v_cvt_pk_bf16_f32 v207, v206, v207
  v_lshlrev_b32 v206, 16, v207
  v_and_b32 v207, 0xffff0000, v207
  v_cvt_pk_bf16_f32 v213, v212, v213
  v_lshlrev_b32 v212, 16, v213
  v_and_b32 v213, 0xffff0000, v213
  v_cvt_pk_bf16_f32 v215, v214, v215
  v_lshlrev_b32 v214, 16, v215
  v_and_b32 v215, 0xffff0000, v215
  v_max3_f32 v230, v84, v85, v86
  v_max3_f32 v231, v87, v92, v93
  v_max3_f32 v230, v230, v94, v95
  v_max3_f32 v231, v231, v100, v101
  v_max3_f32 v230, v230, v102, v103
  v_max3_f32 v231, v231, v108, v109
  v_max3_f32 v230, v230, v110, v111
  v_max3_f32 v231, v231, v116, v117
  v_max3_f32 v230, v230, v118, v119
  v_max3_f32 v231, v231, v124, v125
  v_max3_f32 v230, v230, v126, v127
  buffer_load_dwordx4 v1, s[16:19], s58 offen lds
  s_add_u32 m0, m0, s47
  s_add_u32 s58, s58, 1024
  s_min_u32 s58, s58, 0x3ffc00
  v_max3_f32 v231, v231, v132, v133
  v_max3_f32 v230, v230, v134, v135
  v_max3_f32 v231, v231, v140, v141
  v_max3_f32 v230, v230, v142, v143
  v_max3_f32 v231, v231, v148, v149
  v_max3_f32 v230, v230, v150, v151
  v_max3_f32 v231, v231, v156, v157
  v_max3_f32 v230, v230, v158, v159
  v_max3_f32 v231, v231, v164, v165
  v_max3_f32 v230, v230, v166, v167
  v_max3_f32 v231, v231, v172, v173
  v_max3_f32 v230, v230, v174, v175
  v_max3_f32 v231, v231, v180, v181
  v_max3_f32 v230, v230, v182, v183
  v_max3_f32 v231, v231, v188, v189
  v_max3_f32 v230, v230, v190, v191
  v_max3_f32 v231, v231, v196, v197
  v_max3_f32 v230, v230, v198, v199
  v_max3_f32 v231, v231, v204, v205
  v_max3_f32 v230, v230, v206, v207
  v_max3_f32 v231, v231, v212, v213
  v_max3_f32 v230, v230, v214, v215
  v_max_f32 v230, v230, v231
  v_mov_b32 v232, v230
  s_nop 1
  v_permlane16_swap_b32 v230, v232
  v_max_f32 v230, v230, v232
  v_mov_b32 v232, v230
  s_nop 1
  v_permlane32_swap_b32 v230, v232
  v_max_f32 v230, v230, v232
  v_mul_f32 v230, s53, v230
  v_pk_fma_f32 v[84:85], v[84:85], s[52:53], v[230:231] op_sel_hi:[1,1,0] neg_lo:[0,0,1] neg_hi:[0,0,1]
  v_pk_fma_f32 v[86:87], v[86:87], s[52:53], v[230:231] op_sel_hi:[1,1,0] neg_lo:[0,0,1] neg_hi:[0,0,1]
  v_pk_fma_f32 v[92:93], v[92:93], s[52:53], v[230:231] op_sel_hi:[1,1,0] neg_lo:[0,0,1] neg_hi:[0,0,1]
  v_pk_fma_f32 v[94:95], v[94:95], s[52:53], v[230:231] op_sel_hi:[1,1,0] neg_lo:[0,0,1] neg_hi:[0,0,1]
  v_pk_fma_f32 v[100:101], v[100:101], s[52:53], v[230:231] op_sel_hi:[1,1,0] neg_lo:[0,0,1] neg_hi:[0,0,1]
  v_pk_fma_f32 v[102:103], v[102:103], s[52:53], v[230:231] op_sel_hi:[1,1,0] neg_lo:[0,0,1] neg_hi:[0,0,1]
  v_pk_fma_f32 v[108:109], v[108:109], s[52:53], v[230:231] op_sel_hi:[1,1,0] neg_lo:[0,0,1] neg_hi:[0,0,1]
  v_pk_fma_f32 v[110:111], v[110:111], s[52:53], v[230:231] op_sel_hi:[1,1,0] neg_lo:[0,0,1] neg_hi:[0,0,1]
  v_pk_fma_f32 v[116:117], v[116:117], s[52:53], v[230:231] op_sel_hi:[1,1,0] neg_lo:[0,0,1] neg_hi:[0,0,1]
  v_pk_fma_f32 v[118:119], v[118:119], s[52:53], v[230:231] op_sel_hi:[1,1,0] neg_lo:[0,0,1] neg_hi:[0,0,1]
  v_pk_fma_f32 v[124:125], v[124:125], s[52:53], v[230:231] op_sel_hi:[1,1,0] neg_lo:[0,0,1] neg_hi:[0,0,1]
  v_pk_fma_f32 v[126:127], v[126:127], s[52:53], v[230:231] op_sel_hi:[1,1,0] neg_lo:[0,0,1] neg_hi:[0,0,1]
  v_pk_fma_f32 v[132:133], v[132:133], s[52:53], v[230:231] op_sel_hi:[1,1,0] neg_lo:[0,0,1] neg_hi:[0,0,1]
  v_pk_fma_f32 v[134:135], v[134:135], s[52:53], v[230:231] op_sel_hi:[1,1,0] neg_lo:[0,0,1] neg_hi:[0,0,1]
  v_pk_fma_f32 v[140:141], v[140:141], s[52:53], v[230:231] op_sel_hi:[1,1,0] neg_lo:[0,0,1] neg_hi:[0,0,1]
  v_pk_fma_f32 v[142:143], v[142:143], s[52:53], v[230:231] op_sel_hi:[1,1,0] neg_lo:[0,0,1] neg_hi:[0,0,1]
  v_pk_fma_f32 v[148:149], v[148:149], s[52:53], v[230:231] op_sel_hi:[1,1,0] neg_lo:[0,0,1] neg_hi:[0,0,1]
  v_pk_fma_f32 v[150:151], v[150:151], s[52:53], v[230:231] op_sel_hi:[1,1,0] neg_lo:[0,0,1] neg_hi:[0,0,1]
  v_pk_fma_f32 v[156:157], v[156:157], s[52:53], v[230:231] op_sel_hi:[1,1,0] neg_lo:[0,0,1] neg_hi:[0,0,1]
  v_pk_fma_f32 v[158:159], v[158:159], s[52:53], v[230:231] op_sel_hi:[1,1,0] neg_lo:[0,0,1] neg_hi:[0,0,1]
  v_pk_fma_f32 v[164:165], v[164:165], s[52:53], v[230:231] op_sel_hi:[1,1,0] neg_lo:[0,0,1] neg_hi:[0,0,1]
  v_pk_fma_f32 v[166:167], v[166:167], s[52:53], v[230:231] op_sel_hi:[1,1,0] neg_lo:[0,0,1] neg_hi:[0,0,1]
  v_pk_fma_f32 v[172:173], v[172:173], s[52:53], v[230:231] op_sel_hi:[1,1,0] neg_lo:[0,0,1] neg_hi:[0,0,1]
  v_pk_fma_f32 v[174:175], v[174:175], s[52:53], v[230:231] op_sel_hi:[1,1,0] neg_lo:[0,0,1] neg_hi:[0,0,1]
  v_pk_fma_f32 v[180:181], v[180:181], s[52:53], v[230:231] op_sel_hi:[1,1,0] neg_lo:[0,0,1] neg_hi:[0,0,1]
  v_pk_fma_f32 v[182:183], v[182:183], s[52:53], v[230:231] op_sel_hi:[1,1,0] neg_lo:[0,0,1] neg_hi:[0,0,1]
  buffer_load_dwordx4 v1, s[16:19], s58 offen lds
  s_add_u32 m0, m0, s47
  s_add_u32 s58, s58, 1024
  s_min_u32 s58, s58, 0x3ffc00
  v_pk_fma_f32 v[188:189], v[188:189], s[52:53], v[230:231] op_sel_hi:[1,1,0] neg_lo:[0,0,1] neg_hi:[0,0,1]
  v_pk_fma_f32 v[190:191], v[190:191], s[52:53], v[230:231] op_sel_hi:[1,1,0] neg_lo:[0,0,1] neg_hi:[0,0,1]
  v_pk_fma_f32 v[196:197], v[196:197], s[52:53], v[230:231] op_sel_hi:[1,1,0] neg_lo:[0,0,1] neg_hi:[0,0,1]
  v_pk_fma_f32 v[198:199], v[198:199], s[52:53], v[230:231] op_sel_hi:[1,1,0] neg_lo:[0,0,1] neg_hi:[0,0,1]
  v_pk_fma_f32 v[204:205], v[204:205], s[52:53], v[230:231] op_sel_hi:[1,1,0] neg_lo:[0,0,1] neg_hi:[0,0,1]
  v_pk_fma_f32 v[206:207], v[206:207], s[52:53], v[230:231] op_sel_hi:[1,1,0] neg_lo:[0,0,1] neg_hi:[0,0,1]
  v_pk_fma_f32 v[212:213], v[212:213], s[52:53], v[230:231] op_sel_hi:[1,1,0] neg_lo:[0,0,1] neg_hi:[0,0,1]
  v_pk_fma_f32 v[214:215], v[214:215], s[52:53], v[230:231] op_sel_hi:[1,1,0] neg_lo:[0,0,1] neg_hi:[0,0,1]
  v_exp_f32 v84, v84
  v_exp_f32 v85, v85
  v_exp_f32 v86, v86
  v_exp_f32 v87, v87
  v_exp_f32 v92, v92
  v_exp_f32 v93, v93
  v_exp_f32 v94, v94
  v_exp_f32 v95, v95
  v_exp_f32 v100, v100
  v_exp_f32 v101, v101
  v_exp_f32 v102, v102
  v_exp_f32 v103, v103
  v_exp_f32 v108, v108
  v_exp_f32 v109, v109
  v_exp_f32 v110, v110
  v_exp_f32 v111, v111
  v_exp_f32 v116, v116
  v_exp_f32 v117, v117
  v_exp_f32 v118, v118
  v_exp_f32 v119, v119
  v_exp_f32 v124, v124
  v_exp_f32 v125, v125
  v_exp_f32 v126, v126
  v_exp_f32 v127, v127
  v_exp_f32 v132, v132
  v_exp_f32 v133, v133
  v_exp_f32 v134, v134
  v_exp_f32 v135, v135
  v_exp_f32 v140, v140
  v_exp_f32 v141, v141
  v_exp_f32 v142, v142
  v_exp_f32 v143, v143
  v_exp_f32 v148, v148
  v_exp_f32 v149, v149
  v_exp_f32 v150, v150
  v_exp_f32 v151, v151
  v_exp_f32 v156, v156
  v_exp_f32 v157, v157
  v_exp_f32 v158, v158
  v_exp_f32 v159, v159
  v_exp_f32 v164, v164
  v_exp_f32 v165, v165
  v_exp_f32 v166, v166
  v_exp_f32 v167, v167
  v_exp_f32 v172, v172
  v_exp_f32 v173, v173
  v_exp_f32 v174, v174
  v_exp_f32 v175, v175
  buffer_load_dwordx4 v1, s[16:19], s58 offen lds
  s_add_u32 m0, m0, s47
  s_add_u32 s58, s58, 1024
  s_min_u32 s58, s58, 0x3ffc00
  v_exp_f32 v180, v180
  v_exp_f32 v181, v181
  v_exp_f32 v182, v182
  v_exp_f32 v183, v183
  v_exp_f32 v188, v188
  v_exp_f32 v189, v189
  v_exp_f32 v190, v190
  v_exp_f32 v191, v191
  v_exp_f32 v196, v196
  v_exp_f32 v197, v197
  v_exp_f32 v198, v198
  v_exp_f32 v199, v199
  v_exp_f32 v204, v204
  v_exp_f32 v205, v205
  v_exp_f32 v206, v206
  v_exp_f32 v207, v207
  v_exp_f32 v212, v212
  v_exp_f32 v213, v213
  v_exp_f32 v214, v214
  v_exp_f32 v215, v215
  v_pk_add_f32 v[234:235], v[84:85], v[86:87]
  v_pk_add_f32 v[232:233], v[92:93], v[94:95]
  v_pk_add_f32 v[234:235], v[234:235], v[100:101]
  v_pk_add_f32 v[232:233], v[232:233], v[102:103]
  v_pk_add_f32 v[234:235], v[234:235], v[108:109]
  v_pk_add_f32 v[232:233], v[232:233], v[110:111]
  v_pk_add_f32 v[234:235], v[234:235], v[116:117]
  v_pk_add_f32 v[232:233], v[232:233], v[118:119]
  v_pk_add_f32 v[234:235], v[234:235], v[124:125]
  v_pk_add_f32 v[232:233], v[232:233], v[126:127]
  v_pk_add_f32 v[234:235], v[234:235], v[132:133]
  v_pk_add_f32 v[232:233], v[232:233], v[134:135]
  v_pk_add_f32 v[234:235], v[234:235], v[140:141]
  v_pk_add_f32 v[232:233], v[232:233], v[142:143]
  v_pk_add_f32 v[234:235], v[234:235], v[148:149]
  v_pk_add_f32 v[232:233], v[232:233], v[150:151]
  v_pk_add_f32 v[234:235], v[234:235], v[156:157]
  v_pk_add_f32 v[232:233], v[232:233], v[158:159]
  v_pk_add_f32 v[234:235], v[234:235], v[164:165]
  v_pk_add_f32 v[232:233], v[232:233], v[166:167]
  v_pk_add_f32 v[234:235], v[234:235], v[172:173]
  v_pk_add_f32 v[232:233], v[232:233], v[174:175]
  v_pk_add_f32 v[234:235], v[234:235], v[180:181]
  v_pk_add_f32 v[232:233], v[232:233], v[182:183]
  v_pk_add_f32 v[234:235], v[234:235], v[188:189]
  v_pk_add_f32 v[232:233], v[232:233], v[190:191]
  v_pk_add_f32 v[234:235], v[234:235], v[196:197]
  v_pk_add_f32 v[232:233], v[232:233], v[198:199]
  v_pk_add_f32 v[234:235], v[234:235], v[204:205]
  v_pk_add_f32 v[232:233], v[232:233], v[206:207]
  v_pk_add_f32 v[234:235], v[234:235], v[212:213]
  v_pk_add_f32 v[232:233], v[232:233], v[214:215]
  v_pk_add_f32 v[234:235], v[234:235], v[232:233]
  v_add_f32 v234, v234, v235
  v_mov_b32 v232, v234
  s_nop 1
  v_permlane16_swap_b32 v234, v232
  buffer_load_dwordx4 v1, s[16:19], s58 offen lds
  s_add_u32 m0, m0, s47
  s_add_u32 s58, s58, 1024
  s_min_u32 s58, s58, 0x3ffc00
  v_add_f32 v234, v234, v232
  v_mov_b32 v232, v234
  s_nop 1
  v_permlane32_swap_b32 v234, v232
  v_add_f32 v234, v234, v232
  v_rcp_f32 v234, v234
  s_nop 0
  v_pk_mul_f32 v[84:85], v[84:85], v[234:235] op_sel_hi:[1,0]
  v_pk_mul_f32 v[86:87], v[86:87], v[234:235] op_sel_hi:[1,0]
  v_pk_mul_f32 v[92:93], v[92:93], v[234:235] op_sel_hi:[1,0]
  v_pk_mul_f32 v[94:95], v[94:95], v[234:235] op_sel_hi:[1,0]
  v_pk_mul_f32 v[100:101], v[100:101], v[234:235] op_sel_hi:[1,0]
  v_pk_mul_f32 v[102:103], v[102:103], v[234:235] op_sel_hi:[1,0]
  v_pk_mul_f32 v[108:109], v[108:109], v[234:235] op_sel_hi:[1,0]
  v_pk_mul_f32 v[110:111], v[110:111], v[234:235] op_sel_hi:[1,0]
  v_pk_mul_f32 v[116:117], v[116:117], v[234:235] op_sel_hi:[1,0]
  v_pk_mul_f32 v[118:119], v[118:119], v[234:235] op_sel_hi:[1,0]
  v_pk_mul_f32 v[124:125], v[124:125], v[234:235] op_sel_hi:[1,0]
  v_pk_mul_f32 v[126:127], v[126:127], v[234:235] op_sel_hi:[1,0]
  v_pk_mul_f32 v[132:133], v[132:133], v[234:235] op_sel_hi:[1,0]
  v_pk_mul_f32 v[134:135], v[134:135], v[234:235] op_sel_hi:[1,0]
  v_pk_mul_f32 v[140:141], v[140:141], v[234:235] op_sel_hi:[1,0]
  v_pk_mul_f32 v[142:143], v[142:143], v[234:235] op_sel_hi:[1,0]
  v_pk_mul_f32 v[148:149], v[148:149], v[234:235] op_sel_hi:[1,0]
  v_pk_mul_f32 v[150:151], v[150:151], v[234:235] op_sel_hi:[1,0]
  v_pk_mul_f32 v[156:157], v[156:157], v[234:235] op_sel_hi:[1,0]
  v_pk_mul_f32 v[158:159], v[158:159], v[234:235] op_sel_hi:[1,0]
  v_pk_mul_f32 v[164:165], v[164:165], v[234:235] op_sel_hi:[1,0]
  v_pk_mul_f32 v[166:167], v[166:167], v[234:235] op_sel_hi:[1,0]
  v_pk_mul_f32 v[172:173], v[172:173], v[234:235] op_sel_hi:[1,0]
  v_pk_mul_f32 v[174:175], v[174:175], v[234:235] op_sel_hi:[1,0]
  v_pk_mul_f32 v[180:181], v[180:181], v[234:235] op_sel_hi:[1,0]
  v_pk_mul_f32 v[182:183], v[182:183], v[234:235] op_sel_hi:[1,0]
  v_pk_mul_f32 v[188:189], v[188:189], v[234:235] op_sel_hi:[1,0]
  v_pk_mul_f32 v[190:191], v[190:191], v[234:235] op_sel_hi:[1,0]
  v_pk_mul_f32 v[196:197], v[196:197], v[234:235] op_sel_hi:[1,0]
  v_pk_mul_f32 v[198:199], v[198:199], v[234:235] op_sel_hi:[1,0]
  v_pk_mul_f32 v[204:205], v[204:205], v[234:235] op_sel_hi:[1,0]
  v_pk_mul_f32 v[206:207], v[206:207], v[234:235] op_sel_hi:[1,0]
  v_pk_mul_f32 v[212:213], v[212:213], v[234:235] op_sel_hi:[1,0]
  v_pk_mul_f32 v[214:215], v[214:215], v[234:235] op_sel_hi:[1,0]
  v_cvt_pk_bf16_f32 v84, v84, v85
  v_cvt_pk_bf16_f32 v85, v86, v87
  v_cvt_pk_bf16_f32 v86, v92, v93
  v_cvt_pk_bf16_f32 v87, v94, v95
  v_cvt_pk_bf16_f32 v100, v100, v101
  v_cvt_pk_bf16_f32 v101, v102, v103
  v_cvt_pk_bf16_f32 v102, v108, v109
  v_cvt_pk_bf16_f32 v103, v110, v111
  v_cvt_pk_bf16_f32 v116, v116, v117
  v_cvt_pk_bf16_f32 v117, v118, v119
  v_cvt_pk_bf16_f32 v118, v124, v125
  v_cvt_pk_bf16_f32 v119, v126, v127
  v_cvt_pk_bf16_f32 v132, v132, v133
  v_cvt_pk_bf16_f32 v133, v134, v135
  v_cvt_pk_bf16_f32 v134, v140, v141
  v_cvt_pk_bf16_f32 v135, v142, v143
  v_cvt_pk_bf16_f32 v148, v148, v149
  buffer_load_dwordx4 v1, s[16:19], s58 offen lds
  s_add_u32 m0, m0, s47
  s_add_u32 s58, s58, 1024
  s_min_u32 s58, s58, 0x3ffc00
  v_cvt_pk_bf16_f32 v149, v150, v151
  v_cvt_pk_bf16_f32 v150, v156, v157
  v_cvt_pk_bf16_f32 v151, v158, v159
  v_cvt_pk_bf16_f32 v164, v164, v165
  v_cvt_pk_bf16_f32 v165, v166, v167
  v_cvt_pk_bf16_f32 v166, v172, v173
  v_cvt_pk_bf16_f32 v167, v174, v175
  v_cvt_pk_bf16_f32 v180, v180, v181
  v_cvt_pk_bf16_f32 v181, v182, v183
  v_cvt_pk_bf16_f32 v182, v188, v189
  v_cvt_pk_bf16_f32 v183, v190, v191
  v_cvt_pk_bf16_f32 v196, v196, v197
  v_cvt_pk_bf16_f32 v197, v198, v199
  v_cvt_pk_bf16_f32 v198, v204, v205
  v_cvt_pk_bf16_f32 v199, v206, v207
  v_cvt_pk_bf16_f32 v212, v212, v213
  v_cvt_pk_bf16_f32 v213, v214, v215
  v_mov_b32 v214, 0
  v_mov_b32 v215, 0
  s_waitcnt vmcnt(7)
  v_mfma_f32_16x16x32_bf16 v[236:239], v[48:51], v[84:87], 0
  v_mfma_f32_16x16x32_bf16 v[236:239], v[52:55], v[100:103], v[236:239]
  v_mfma_f32_16x16x32_bf16 v[236:239], v[56:59], v[116:119], v[236:239]
  v_mfma_f32_16x16x32_bf16 v[236:239], v[60:63], v[132:135], v[236:239]
  v_mfma_f32_16x16x32_bf16 v[236:239], v[64:67], v[148:151], v[236:239]
  v_mfma_f32_16x16x32_bf16 v[236:239], v[68:71], v[164:167], v[236:239]
  v_mfma_f32_16x16x32_bf16 v[236:239], v[72:75], v[180:183], v[236:239]
  v_mfma_f32_16x16x32_bf16 v[236:239], v[76:79], v[196:199], v[236:239]
  v_mfma_f32_16x16x32_bf16 v[236:239], v[80:83], v[212:215], v[236:239]
  v_cvt_pk_bf16_f32 v97, v96, v97
  v_lshlrev_b32 v96, 16, v97
  v_and_b32 v97, 0xffff0000, v97
  v_cvt_pk_bf16_f32 v99, v98, v99
  v_lshlrev_b32 v98, 16, v99
  v_and_b32 v99, 0xffff0000, v99
  v_cvt_pk_bf16_f32 v105, v104, v105
  v_lshlrev_b32 v104, 16, v105
  v_and_b32 v105, 0xffff0000, v105
  v_cvt_pk_bf16_f32 v107, v106, v107
  v_lshlrev_b32 v106, 16, v107
  v_and_b32 v107, 0xffff0000, v107
  v_cvt_pk_bf16_f32 v113, v112, v113
  v_lshlrev_b32 v112, 16, v113
  v_and_b32 v113, 0xffff0000, v113
  v_cvt_pk_bf16_f32 v115, v114, v115
  v_lshlrev_b32 v114, 16, v115
  v_and_b32 v115, 0xffff0000, v115
  v_cvt_pk_bf16_f32 v121, v120, v121
  v_lshlrev_b32 v120, 16, v121
  v_and_b32 v121, 0xffff0000, v121
  v_cvt_pk_bf16_f32 v123, v122, v123
  v_lshlrev_b32 v122, 16, v123
  v_and_b32 v123, 0xffff0000, v123
  v_cvt_pk_bf16_f32 v129, v128, v129
  v_lshlrev_b32 v128, 16, v129
  v_and_b32 v129, 0xffff0000, v129
  buffer_load_dwordx4 v1, s[16:19], s58 offen lds
  s_add_u32 m0, m0, s47
  s_add_u32 s58, s58, 1024
  s_min_u32 s58, s58, 0x3ffc00
  v_cvt_pk_bf16_f32 v131, v130, v131
  v_lshlrev_b32 v130, 16, v131
  v_and_b32 v131, 0xffff0000, v131
  v_cvt_pk_bf16_f32 v137, v136, v137
  v_lshlrev_b32 v136, 16, v137
  v_and_b32 v137, 0xffff0000, v137
  v_cvt_pk_bf16_f32 v139, v138, v139
  v_lshlrev_b32 v138, 16, v139
  v_and_b32 v139, 0xffff0000, v139
  v_cvt_pk_bf16_f32 v145, v144, v145
  v_lshlrev_b32 v144, 16, v145
  v_and_b32 v145, 0xffff0000, v145
  v_cvt_pk_bf16_f32 v147, v146, v147
  v_lshlrev_b32 v146, 16, v147
  v_and_b32 v147, 0xffff0000, v147
  v_cvt_pk_bf16_f32 v153, v152, v153
  v_lshlrev_b32 v152, 16, v153
  v_and_b32 v153, 0xffff0000, v153
  v_cvt_pk_bf16_f32 v155, v154, v155
  v_lshlrev_b32 v154, 16, v155
  v_and_b32 v155, 0xffff0000, v155
  v_cvt_pk_bf16_f32 v161, v160, v161
  v_lshlrev_b32 v160, 16, v161
  v_and_b32 v161, 0xffff0000, v161
  v_cvt_pk_bf16_f32 v163, v162, v163
  v_lshlrev_b32 v162, 16, v163
  v_and_b32 v163, 0xffff0000, v163
  v_cvt_pk_bf16_f32 v169, v168, v169
  v_lshlrev_b32 v168, 16, v169
  v_and_b32 v169, 0xffff0000, v169
  v_cvt_pk_bf16_f32 v171, v170, v171
  v_lshlrev_b32 v170, 16, v171
  v_and_b32 v171, 0xffff0000, v171
  v_cvt_pk_bf16_f32 v177, v176, v177
  v_lshlrev_b32 v176, 16, v177
  v_and_b32 v177, 0xffff0000, v177
  v_cvt_pk_bf16_f32 v179, v178, v179
  v_lshlrev_b32 v178, 16, v179
  v_and_b32 v179, 0xffff0000, v179
  v_cvt_pk_bf16_f32 v185, v184, v185
  v_lshlrev_b32 v184, 16, v185
  v_and_b32 v185, 0xffff0000, v185
  v_cvt_pk_bf16_f32 v187, v186, v187
  v_lshlrev_b32 v186, 16, v187
  v_and_b32 v187, 0xffff0000, v187
  v_cvt_pk_bf16_f32 v193, v192, v193
  v_lshlrev_b32 v192, 16, v193
  v_and_b32 v193, 0xffff0000, v193
  v_cvt_pk_bf16_f32 v195, v194, v195
  v_lshlrev_b32 v194, 16, v195
  v_and_b32 v195, 0xffff0000, v195
  v_cvt_pk_bf16_f32 v201, v200, v201
  v_lshlrev_b32 v200, 16, v201
  v_and_b32 v201, 0xffff0000, v201
  v_cvt_pk_bf16_f32 v203, v202, v203
  v_lshlrev_b32 v202, 16, v203
  buffer_load_dwordx4 v1, s[16:19], s58 offen lds
  s_add_u32 m0, m0, s47
  s_add_u32 s58, s58, 1024
  s_min_u32 s58, s58, 0x3ffc00
  v_and_b32 v203, 0xffff0000, v203
  v_cvt_pk_bf16_f32 v209, v208, v209
  v_lshlrev_b32 v208, 16, v209
  v_and_b32 v209, 0xffff0000, v209
  v_cvt_pk_bf16_f32 v211, v210, v211
  v_lshlrev_b32 v210, 16, v211
  v_and_b32 v211, 0xffff0000, v211
  v_cvt_pk_bf16_f32 v217, v216, v217
  v_lshlrev_b32 v216, 16, v217
  v_and_b32 v217, 0xffff0000, v217
  v_cvt_pk_bf16_f32 v219, v218, v219
  v_lshlrev_b32 v218, 16, v219
  v_and_b32 v219, 0xffff0000, v219
  v_cvt_pk_bf16_f32 v225, v224, v225
  v_lshlrev_b32 v224, 16, v225
  v_and_b32 v225, 0xffff0000, v225
  v_cvt_pk_bf16_f32 v227, v226, v227
  v_lshlrev_b32 v226, 16, v227
  v_and_b32 v227, 0xffff0000, v227
  v_max3_f32 v230, v96, v97, v98
  v_max3_f32 v231, v99, v104, v105
  v_max3_f32 v230, v230, v106, v107
  v_max3_f32 v231, v231, v112, v113
  v_max3_f32 v230, v230, v114, v115
  v_max3_f32 v231, v231, v120, v121
  v_max3_f32 v230, v230, v122, v123
  v_max3_f32 v231, v231, v128, v129
  v_max3_f32 v230, v230, v130, v131
  v_max3_f32 v231, v231, v136, v137
  v_max3_f32 v230, v230, v138, v139
  v_max3_f32 v231, v231, v144, v145
  v_max3_f32 v230, v230, v146, v147
  v_max3_f32 v231, v231, v152, v153
  v_max3_f32 v230, v230, v154, v155
  v_max3_f32 v231, v231, v160, v161
  v_max3_f32 v230, v230, v162, v163
  v_max3_f32 v231, v231, v168, v169
  v_max3_f32 v230, v230, v170, v171
  v_max3_f32 v231, v231, v176, v177
  v_max3_f32 v230, v230, v178, v179
  v_max3_f32 v231, v231, v184, v185
  v_max3_f32 v230, v230, v186, v187
  v_max3_f32 v231, v231, v192, v193
  v_max3_f32 v230, v230, v194, v195
  v_max3_f32 v231, v231, v200, v201
  v_max3_f32 v230, v230, v202, v203
  v_max3_f32 v231, v231, v208, v209
  v_max3_f32 v230, v230, v210, v211
  v_max3_f32 v231, v231, v216, v217
  v_max3_f32 v230, v230, v218, v219
  v_max3_f32 v231, v231, v224, v225
  v_max3_f32 v230, v230, v226, v227
  v_max_f32 v230, v230, v231
  v_mov_b32 v232, v230
  s_nop 1
  v_permlane16_swap_b32 v230, v232
  v_max_f32 v230, v230, v232
  buffer_load_dwordx4 v1, s[16:19], s58 offen lds
  s_add_u32 m0, m0, s47
  s_add_u32 s58, s58, 1024
  s_min_u32 s58, s58, 0x3ffc00
  v_mov_b32 v232, v230
  s_nop 1
  v_permlane32_swap_b32 v230, v232
  v_max_f32 v230, v230, v232
  v_mul_f32 v230, s53, v230
  v_pk_fma_f32 v[96:97], v[96:97], s[52:53], v[230:231] op_sel_hi:[1,1,0] neg_lo:[0,0,1] neg_hi:[0,0,1]
  v_pk_fma_f32 v[98:99], v[98:99], s[52:53], v[230:231] op_sel_hi:[1,1,0] neg_lo:[0,0,1] neg_hi:[0,0,1]
  v_pk_fma_f32 v[104:105], v[104:105], s[52:53], v[230:231] op_sel_hi:[1,1,0] neg_lo:[0,0,1] neg_hi:[0,0,1]
  v_pk_fma_f32 v[106:107], v[106:107], s[52:53], v[230:231] op_sel_hi:[1,1,0] neg_lo:[0,0,1] neg_hi:[0,0,1]
  v_pk_fma_f32 v[112:113], v[112:113], s[52:53], v[230:231] op_sel_hi:[1,1,0] neg_lo:[0,0,1] neg_hi:[0,0,1]
  v_pk_fma_f32 v[114:115], v[114:115], s[52:53], v[230:231] op_sel_hi:[1,1,0] neg_lo:[0,0,1] neg_hi:[0,0,1]
  v_pk_fma_f32 v[120:121], v[120:121], s[52:53], v[230:231] op_sel_hi:[1,1,0] neg_lo:[0,0,1] neg_hi:[0,0,1]
  v_pk_fma_f32 v[122:123], v[122:123], s[52:53], v[230:231] op_sel_hi:[1,1,0] neg_lo:[0,0,1] neg_hi:[0,0,1]
  v_pk_fma_f32 v[128:129], v[128:129], s[52:53], v[230:231] op_sel_hi:[1,1,0] neg_lo:[0,0,1] neg_hi:[0,0,1]
  v_pk_fma_f32 v[130:131], v[130:131], s[52:53], v[230:231] op_sel_hi:[1,1,0] neg_lo:[0,0,1] neg_hi:[0,0,1]
  v_pk_fma_f32 v[136:137], v[136:137], s[52:53], v[230:231] op_sel_hi:[1,1,0] neg_lo:[0,0,1] neg_hi:[0,0,1]
  v_pk_fma_f32 v[138:139], v[138:139], s[52:53], v[230:231] op_sel_hi:[1,1,0] neg_lo:[0,0,1] neg_hi:[0,0,1]
  v_pk_fma_f32 v[144:145], v[144:145], s[52:53], v[230:231] op_sel_hi:[1,1,0] neg_lo:[0,0,1] neg_hi:[0,0,1]
  v_pk_fma_f32 v[146:147], v[146:147], s[52:53], v[230:231] op_sel_hi:[1,1,0] neg_lo:[0,0,1] neg_hi:[0,0,1]
  v_pk_fma_f32 v[152:153], v[152:153], s[52:53], v[230:231] op_sel_hi:[1,1,0] neg_lo:[0,0,1] neg_hi:[0,0,1]
  v_pk_fma_f32 v[154:155], v[154:155], s[52:53], v[230:231] op_sel_hi:[1,1,0] neg_lo:[0,0,1] neg_hi:[0,0,1]
  v_pk_fma_f32 v[160:161], v[160:161], s[52:53], v[230:231] op_sel_hi:[1,1,0] neg_lo:[0,0,1] neg_hi:[0,0,1]
  v_pk_fma_f32 v[162:163], v[162:163], s[52:53], v[230:231] op_sel_hi:[1,1,0] neg_lo:[0,0,1] neg_hi:[0,0,1]
  v_pk_fma_f32 v[168:169], v[168:169], s[52:53], v[230:231] op_sel_hi:[1,1,0] neg_lo:[0,0,1] neg_hi:[0,0,1]
  v_pk_fma_f32 v[170:171], v[170:171], s[52:53], v[230:231] op_sel_hi:[1,1,0] neg_lo:[0,0,1] neg_hi:[0,0,1]
  v_pk_fma_f32 v[176:177], v[176:177], s[52:53], v[230:231] op_sel_hi:[1,1,0] neg_lo:[0,0,1] neg_hi:[0,0,1]
  v_pk_fma_f32 v[178:179], v[178:179], s[52:53], v[230:231] op_sel_hi:[1,1,0] neg_lo:[0,0,1] neg_hi:[0,0,1]
  v_pk_fma_f32 v[184:185], v[184:185], s[52:53], v[230:231] op_sel_hi:[1,1,0] neg_lo:[0,0,1] neg_hi:[0,0,1]
  v_pk_fma_f32 v[186:187], v[186:187], s[52:53], v[230:231] op_sel_hi:[1,1,0] neg_lo:[0,0,1] neg_hi:[0,0,1]
  v_pk_fma_f32 v[192:193], v[192:193], s[52:53], v[230:231] op_sel_hi:[1,1,0] neg_lo:[0,0,1] neg_hi:[0,0,1]
  v_pk_fma_f32 v[194:195], v[194:195], s[52:53], v[230:231] op_sel_hi:[1,1,0] neg_lo:[0,0,1] neg_hi:[0,0,1]
  v_pk_fma_f32 v[200:201], v[200:201], s[52:53], v[230:231] op_sel_hi:[1,1,0] neg_lo:[0,0,1] neg_hi:[0,0,1]
  v_pk_fma_f32 v[202:203], v[202:203], s[52:53], v[230:231] op_sel_hi:[1,1,0] neg_lo:[0,0,1] neg_hi:[0,0,1]
  v_pk_fma_f32 v[208:209], v[208:209], s[52:53], v[230:231] op_sel_hi:[1,1,0] neg_lo:[0,0,1] neg_hi:[0,0,1]
  v_pk_fma_f32 v[210:211], v[210:211], s[52:53], v[230:231] op_sel_hi:[1,1,0] neg_lo:[0,0,1] neg_hi:[0,0,1]
  v_pk_fma_f32 v[216:217], v[216:217], s[52:53], v[230:231] op_sel_hi:[1,1,0] neg_lo:[0,0,1] neg_hi:[0,0,1]
  v_pk_fma_f32 v[218:219], v[218:219], s[52:53], v[230:231] op_sel_hi:[1,1,0] neg_lo:[0,0,1] neg_hi:[0,0,1]
  v_pk_fma_f32 v[224:225], v[224:225], s[52:53], v[230:231] op_sel_hi:[1,1,0] neg_lo:[0,0,1] neg_hi:[0,0,1]
  v_pk_fma_f32 v[226:227], v[226:227], s[52:53], v[230:231] op_sel_hi:[1,1,0] neg_lo:[0,0,1] neg_hi:[0,0,1]
  v_exp_f32 v96, v96
  v_exp_f32 v97, v97
  v_exp_f32 v98, v98
  v_exp_f32 v99, v99
  v_exp_f32 v104, v104
  v_exp_f32 v105, v105
  v_exp_f32 v106, v106
  v_exp_f32 v107, v107
  v_exp_f32 v112, v112
  v_exp_f32 v113, v113
  v_exp_f32 v114, v114
  v_exp_f32 v115, v115
  v_exp_f32 v120, v120
  v_exp_f32 v121, v121
  v_exp_f32 v122, v122
  v_exp_f32 v123, v123
  v_exp_f32 v128, v128
  v_exp_f32 v129, v129
  buffer_load_dwordx4 v1, s[16:19], s58 offen lds
  s_add_u32 m0, m0, s47
  s_add_u32 s58, s58, 1024
  s_min_u32 s58, s58, 0x3ffc00
  v_exp_f32 v130, v130
  v_exp_f32 v131, v131
  v_exp_f32 v136, v136
  v_exp_f32 v137, v137
  v_exp_f32 v138, v138
  v_exp_f32 v139, v139
  v_exp_f32 v144, v144
  v_exp_f32 v145, v145
  v_exp_f32 v146, v146
  v_exp_f32 v147, v147
  v_exp_f32 v152, v152
  v_exp_f32 v153, v153
  v_exp_f32 v154, v154
  v_exp_f32 v155, v155
  v_exp_f32 v160, v160
  v_exp_f32 v161, v161
  v_exp_f32 v162, v162
  v_exp_f32 v163, v163
  v_exp_f32 v168, v168
  v_exp_f32 v169, v169
  v_exp_f32 v170, v170
  v_exp_f32 v171, v171
  v_exp_f32 v176, v176
  v_exp_f32 v177, v177
  v_exp_f32 v178, v178
  v_exp_f32 v179, v179
  v_exp_f32 v184, v184
  v_exp_f32 v185, v185
  v_exp_f32 v186, v186
  v_exp_f32 v187, v187
  v_exp_f32 v192, v192
  v_exp_f32 v193, v193
  v_exp_f32 v194, v194
  v_exp_f32 v195, v195
  v_exp_f32 v200, v200
  v_exp_f32 v201, v201
  v_exp_f32 v202, v202
  v_exp_f32 v203, v203
  v_exp_f32 v208, v208
  v_exp_f32 v209, v209
  v_exp_f32 v210, v210
  v_exp_f32 v211, v211
  v_exp_f32 v216, v216
  v_exp_f32 v217, v217
  v_exp_f32 v218, v218
  v_exp_f32 v219, v219
  v_exp_f32 v224, v224
  v_exp_f32 v225, v225
  v_exp_f32 v226, v226
  v_exp_f32 v227, v227
  v_pk_add_f32 v[234:235], v[96:97], v[98:99]
  v_pk_add_f32 v[232:233], v[104:105], v[106:107]
  v_pk_add_f32 v[234:235], v[234:235], v[112:113]
  v_pk_add_f32 v[232:233], v[232:233], v[114:115]
  v_pk_add_f32 v[234:235], v[234:235], v[120:121]
  v_pk_add_f32 v[232:233], v[232:233], v[122:123]
  v_pk_add_f32 v[234:235], v[234:235], v[128:129]
  v_pk_add_f32 v[232:233], v[232:233], v[130:131]
  v_pk_add_f32 v[234:235], v[234:235], v[136:137]
  v_pk_add_f32 v[232:233], v[232:233], v[138:139]
  v_pk_add_f32 v[234:235], v[234:235], v[144:145]
  v_pk_add_f32 v[232:233], v[232:233], v[146:147]
  v_pk_add_f32 v[234:235], v[234:235], v[152:153]
  v_pk_add_f32 v[232:233], v[232:233], v[154:155]
  v_pk_add_f32 v[234:235], v[234:235], v[160:161]
  v_pk_add_f32 v[232:233], v[232:233], v[162:163]
  v_pk_add_f32 v[234:235], v[234:235], v[168:169]
  v_pk_add_f32 v[232:233], v[232:233], v[170:171]
  v_pk_add_f32 v[234:235], v[234:235], v[176:177]
  v_pk_add_f32 v[232:233], v[232:233], v[178:179]
  v_pk_add_f32 v[234:235], v[234:235], v[184:185]
  v_pk_add_f32 v[232:233], v[232:233], v[186:187]
  v_pk_add_f32 v[234:235], v[234:235], v[192:193]
  v_pk_add_f32 v[232:233], v[232:233], v[194:195]
  v_pk_add_f32 v[234:235], v[234:235], v[200:201]
  v_pk_add_f32 v[232:233], v[232:233], v[202:203]
  v_pk_add_f32 v[234:235], v[234:235], v[208:209]
  v_pk_add_f32 v[232:233], v[232:233], v[210:211]
  v_pk_add_f32 v[234:235], v[234:235], v[216:217]
  v_pk_add_f32 v[232:233], v[232:233], v[218:219]
  v_pk_add_f32 v[234:235], v[234:235], v[224:225]
  v_pk_add_f32 v[232:233], v[232:233], v[226:227]
  v_pk_add_f32 v[234:235], v[234:235], v[232:233]
  v_add_f32 v234, v234, v235
  v_mov_b32 v232, v234
  s_nop 1
  v_permlane16_swap_b32 v234, v232
  v_add_f32 v234, v234, v232
  v_mov_b32 v232, v234
  s_nop 1
  v_permlane32_swap_b32 v234, v232
  v_add_f32 v234, v234, v232
  v_rcp_f32 v234, v234
  s_nop 0
  v_pk_mul_f32 v[96:97], v[96:97], v[234:235] op_sel_hi:[1,0]
  v_pk_mul_f32 v[98:99], v[98:99], v[234:235] op_sel_hi:[1,0]
  v_pk_mul_f32 v[104:105], v[104:105], v[234:235] op_sel_hi:[1,0]
  v_pk_mul_f32 v[106:107], v[106:107], v[234:235] op_sel_hi:[1,0]
  v_pk_mul_f32 v[112:113], v[112:113], v[234:235] op_sel_hi:[1,0]
  v_pk_mul_f32 v[114:115], v[114:115], v[234:235] op_sel_hi:[1,0]
  v_pk_mul_f32 v[120:121], v[120:121], v[234:235] op_sel_hi:[1,0]
  v_pk_mul_f32 v[122:123], v[122:123], v[234:235] op_sel_hi:[1,0]
  v_pk_mul_f32 v[128:129], v[128:129], v[234:235] op_sel_hi:[1,0]
  v_pk_mul_f32 v[130:131], v[130:131], v[234:235] op_sel_hi:[1,0]
  v_pk_mul_f32 v[136:137], v[136:137], v[234:235] op_sel_hi:[1,0]
  v_pk_mul_f32 v[138:139], v[138:139], v[234:235] op_sel_hi:[1,0]
  v_pk_mul_f32 v[144:145], v[144:145], v[234:235] op_sel_hi:[1,0]
  v_pk_mul_f32 v[146:147], v[146:147], v[234:235] op_sel_hi:[1,0]
  v_pk_mul_f32 v[152:153], v[152:153], v[234:235] op_sel_hi:[1,0]
  v_pk_mul_f32 v[154:155], v[154:155], v[234:235] op_sel_hi:[1,0]
  v_pk_mul_f32 v[160:161], v[160:161], v[234:235] op_sel_hi:[1,0]
  v_pk_mul_f32 v[162:163], v[162:163], v[234:235] op_sel_hi:[1,0]
  v_pk_mul_f32 v[168:169], v[168:169], v[234:235] op_sel_hi:[1,0]
  v_pk_mul_f32 v[170:171], v[170:171], v[234:235] op_sel_hi:[1,0]
  v_pk_mul_f32 v[176:177], v[176:177], v[234:235] op_sel_hi:[1,0]
  v_pk_mul_f32 v[178:179], v[178:179], v[234:235] op_sel_hi:[1,0]
  v_pk_mul_f32 v[184:185], v[184:185], v[234:235] op_sel_hi:[1,0]
  v_pk_mul_f32 v[186:187], v[186:187], v[234:235] op_sel_hi:[1,0]
  v_pk_mul_f32 v[192:193], v[192:193], v[234:235] op_sel_hi:[1,0]
  v_pk_mul_f32 v[194:195], v[194:195], v[234:235] op_sel_hi:[1,0]
  v_pk_mul_f32 v[200:201], v[200:201], v[234:235] op_sel_hi:[1,0]
  v_pk_mul_f32 v[202:203], v[202:203], v[234:235] op_sel_hi:[1,0]
  v_pk_mul_f32 v[208:209], v[208:209], v[234:235] op_sel_hi:[1,0]
  v_pk_mul_f32 v[210:211], v[210:211], v[234:235] op_sel_hi:[1,0]
  v_pk_mul_f32 v[216:217], v[216:217], v[234:235] op_sel_hi:[1,0]
  v_pk_mul_f32 v[218:219], v[218:219], v[234:235] op_sel_hi:[1,0]
  v_pk_mul_f32 v[224:225], v[224:225], v[234:235] op_sel_hi:[1,0]
  v_pk_mul_f32 v[226:227], v[226:227], v[234:235] op_sel_hi:[1,0]
  v_mov_b32 v88, 0
  v_mov_b32 v89, 0
  v_cvt_pk_bf16_f32 v90, v96, v97
  v_cvt_pk_bf16_f32 v91, v98, v99
  v_cvt_pk_bf16_f32 v104, v104, v105
  v_cvt_pk_bf16_f32 v105, v106, v107
  v_cvt_pk_bf16_f32 v106, v112, v113
  v_cvt_pk_bf16_f32 v107, v114, v115
  v_cvt_pk_bf16_f32 v120, v120, v121
  v_cvt_pk_bf16_f32 v121, v122, v123
  v_cvt_pk_bf16_f32 v122, v128, v129
  v_cvt_pk_bf16_f32 v123, v130, v131
  v_cvt_pk_bf16_f32 v136, v136, v137
  v_cvt_pk_bf16_f32 v137, v138, v139
  v_cvt_pk_bf16_f32 v138, v144, v145
  v_cvt_pk_bf16_f32 v139, v146, v147
  v_cvt_pk_bf16_f32 v152, v152, v153
  v_cvt_pk_bf16_f32 v153, v154, v155
  v_cvt_pk_bf16_f32 v154, v160, v161
  v_cvt_pk_bf16_f32 v155, v162, v163
  v_cvt_pk_bf16_f32 v168, v168, v169
  v_cvt_pk_bf16_f32 v169, v170, v171
  v_cvt_pk_bf16_f32 v170, v176, v177
  v_cvt_pk_bf16_f32 v171, v178, v179
  v_cvt_pk_bf16_f32 v184, v184, v185
  v_cvt_pk_bf16_f32 v185, v186, v187
  v_cvt_pk_bf16_f32 v186, v192, v193
  v_cvt_pk_bf16_f32 v187, v194, v195
  v_cvt_pk_bf16_f32 v200, v200, v201
  v_cvt_pk_bf16_f32 v201, v202, v203
  v_cvt_pk_bf16_f32 v202, v208, v209
  v_cvt_pk_bf16_f32 v203, v210, v211
  v_cvt_pk_bf16_f32 v216, v216, v217
  v_cvt_pk_bf16_f32 v217, v218, v219
  v_cvt_pk_bf16_f32 v218, v224, v225
  v_cvt_pk_bf16_f32 v219, v226, v227
  v_mfma_f32_16x16x32_bf16 v[240:243], v[48:51], v[88:91], 0
  v_mfma_f32_16x16x32_bf16 v[240:243], v[52:55], v[104:107], v[240:243]
  v_mfma_f32_16x16x32_bf16 v[240:243], v[56:59], v[120:123], v[240:243]
  v_mfma_f32_16x16x32_bf16 v[240:243], v[60:63], v[136:139], v[240:243]
  v_mfma_f32_16x16x32_bf16 v[240:243], v[64:67], v[152:155], v[240:243]
  v_mfma_f32_16x16x32_bf16 v[240:243], v[68:71], v[168:171], v[240:243]
  v_mfma_f32_16x16x32_bf16 v[240:243], v[72:75], v[184:187], v[240:243]
  v_mfma_f32_16x16x32_bf16 v[240:243], v[76:79], v[200:203], v[240:243]
  v_mfma_f32_16x16x32_bf16 v[240:243], v[80:83], v[216:219], v[240:243]
  v_cvt_pk_bf16_f32 v8, v236, v237
  v_cvt_pk_bf16_f32 v9, v238, v239
  s_nop 5
  v_cvt_pk_bf16_f32 v10, v240, v241
  v_cvt_pk_bf16_f32 v11, v242, v243
  s_lshl_b32 s55, s49, 15
  s_lshr_b32 s56, s40, 1
  s_lshl_b32 s56, s56, 10
  s_add_u32 s55, s55, s56
  s_and_b32 s56, s40, 1
  s_lshl_b32 s56, s56, 3
  s_add_u32 s55, s55, s56
  s_add_u32 s55, s55, 0x4c00000
  s_add_u32 s56, s55, 16384
  buffer_store_dwordx2 v[8:9], v1, s[8:11], s55 offen sc1
  buffer_store_dwordx2 v[10:11], v1, s[8:11], s56 offen sc1
  s_branch L_ba_skip
L_ba_only:
  s_mov_b32 s56, 11
L_ba_dl:
  buffer_load_dwordx4 v1, s[16:19], s58 offen lds
  s_add_u32 m0, m0, s47
  s_add_u32 s58, s58, 1024
  s_min_u32 s58, s58, 0x3ffc00
  s_sub_u32 s56, s56, 1
  s_cmp_lg_u32 s56, 0
  s_cbranch_scc1 L_ba_dl
L_ba_skip:
  s_add_u32 s44, s44, 4
  s_waitcnt vmcnt(0)
  s_add_u32 s61, s61, 1
  s_cmp_lt_u32 s61, 3
  s_cbranch_scc1 L_ba_loop
L_ba_end:
  s_barrier
  s_lshl_b32 s48, s40, 3
  s_add_u32 s48, s48, s42
  s_lshl_b32 s48, s48, 2
  s_add_u32 s48, s48, 0x40a1400
  v_mov_b32 v7, 1
  v_mov_b32 v6, 0
  s_mov_b64 exec, 1
  buffer_store_dword v7, v6, s[8:11], s48 offen sc1
  s_mov_b64 exec, -1
  s_barrier
  v_add_u32 v2, 81920, v3
  ds_read_b64_tr_b16 a[0:1], v3 offset:0
  ds_read_b64_tr_b16 a[2:3], v3 offset:16896
  ds_read_b64_tr_b16 a[4:5], v3 offset:40960
  ds_read_b64_tr_b16 a[6:7], v3 offset:57856
  ds_read_b64_tr_b16 a[8:9], v2 offset:0
  ds_read_b64_tr_b16 a[10:11], v2 offset:16896
  ds_read_b64_tr_b16 a[12:13], v2 offset:40960
  ds_read_b64_tr_b16 a[14:15], v2 offset:57856
  s_waitcnt lgkmcnt(0)
  ds_read_b64_tr_b16 a[16:17], v3 offset:32
  ds_read_b64_tr_b16 a[18:19], v3 offset:16928
  ds_read_b64_tr_b16 a[20:21], v3 offset:40992
  ds_read_b64_tr_b16 a[22:23], v3 offset:57888
  ds_read_b64_tr_b16 a[24:25], v2 offset:32
  ds_read_b64_tr_b16 a[26:27], v2 offset:16928
  ds_read_b64_tr_b16 a[28:29], v2 offset:40992
  ds_read_b64_tr_b16 a[30:31], v2 offset:57888
  s_waitcnt lgkmcnt(0)
  ds_read_b64_tr_b16 a[32:33], v3 offset:64
  ds_read_b64_tr_b16 a[34:35], v3 offset:16960
  ds_read_b64_tr_b16 a[36:37], v3 offset:41024
  ds_read_b64_tr_b16 a[38:39], v3 offset:57920
  ds_read_b64_tr_b16 a[40:41], v2 offset:64
  ds_read_b64_tr_b16 a[42:43], v2 offset:16960
  ds_read_b64_tr_b16 a[44:45], v2 offset:41024
  ds_read_b64_tr_b16 a[46:47], v2 offset:57920
  s_waitcnt lgkmcnt(0)
  ds_read_b64_tr_b16 a[48:49], v3 offset:96
  ds_read_b64_tr_b16 a[50:51], v3 offset:16992
  ds_read_b64_tr_b16 a[52:53], v3 offset:41056
  ds_read_b64_tr_b16 a[54:55], v3 offset:57952
  ds_read_b64_tr_b16 a[56:57], v2 offset:96
  ds_read_b64_tr_b16 a[58:59], v2 offset:16992
  ds_read_b64_tr_b16 a[60:61], v2 offset:41056
  ds_read_b64_tr_b16 a[62:63], v2 offset:57952
  s_waitcnt lgkmcnt(0)
  ds_read_b64_tr_b16 a[64:65], v3 offset:128
  ds_read_b64_tr_b16 a[66:67], v3 offset:17024
  ds_read_b64_tr_b16 a[68:69], v3 offset:41088
  ds_read_b64_tr_b16 a[70:71], v3 offset:57984
  ds_read_b64_tr_b16 a[72:73], v2 offset:128
  ds_read_b64_tr_b16 a[74:75], v2 offset:17024
  ds_read_b64_tr_b16 a[76:77], v2 offset:41088
  ds_read_b64_tr_b16 a[78:79], v2 offset:57984
  s_waitcnt lgkmcnt(0)
  ds_read_b64_tr_b16 a[80:81], v3 offset:160
  ds_read_b64_tr_b16 a[82:83], v3 offset:17056
  ds_read_b64_tr_b16 a[84:85], v3 offset:41120
  ds_read_b64_tr_b16 a[86:87], v3 offset:58016
  ds_read_b64_tr_b16 a[88:89], v2 offset:160
  ds_read_b64_tr_b16 a[90:91], v2 offset:17056
  ds_read_b64_tr_b16 a[92:93], v2 offset:41120
  ds_read_b64_tr_b16 a[94:95], v2 offset:58016
  s_waitcnt lgkmcnt(0)
  ds_read_b64_tr_b16 a[96:97], v3 offset:192
  ds_read_b64_tr_b16 a[98:99], v3 offset:17088
  ds_read_b64_tr_b16 a[100:101], v3 offset:41152
  ds_read_b64_tr_b16 a[102:103], v3 offset:58048
  ds_read_b64_tr_b16 a[104:105], v2 offset:192
  ds_read_b64_tr_b16 a[106:107], v2 offset:17088
  ds_read_b64_tr_b16 a[108:109], v2 offset:41152
  ds_read_b64_tr_b16 a[110:111], v2 offset:58048
  s_waitcnt lgkmcnt(0)
  ds_read_b64_tr_b16 a[112:113], v3 offset:224
  ds_read_b64_tr_b16 a[114:115], v3 offset:17120
  ds_read_b64_tr_b16 a[116:117], v3 offset:41184
  ds_read_b64_tr_b16 a[118:119], v3 offset:58080
  ds_read_b64_tr_b16 a[120:121], v2 offset:224
  ds_read_b64_tr_b16 a[122:123], v2 offset:17120
  ds_read_b64_tr_b16 a[124:125], v2 offset:41184
  ds_read_b64_tr_b16 a[126:127], v2 offset:58080
  s_waitcnt lgkmcnt(0)
  v_lshlrev_b32 v6, 3, v0
  v_add_u32 v6, s63, v6
  ds_read_b64_tr_b16 v[112:113], v6 offset:36864
  ds_read_b64_tr_b16 v[114:115], v6 offset:37376
  ds_read_b64_tr_b16 v[116:117], v6 offset:37888
  ds_read_b64_tr_b16 v[118:119], v6 offset:38400
  ds_read_b64_tr_b16 v[120:121], v6 offset:38912
  ds_read_b64_tr_b16 v[122:123], v6 offset:39424
  ds_read_b64_tr_b16 v[124:125], v6 offset:39936
  ds_read_b64_tr_b16 v[126:127], v6 offset:40448
  s_waitcnt lgkmcnt(0)
  s_mov_b32 s40, s51
  s_mov_b32 s12, s86
  s_and_b32 s13, s87, 0xffff
  s_mov_b32 s14, 0x200000
  s_mov_b32 s15, 0x00020000
  s_barrier
  s_mul_i32 s57, s41, 12288
  s_add_u32 s57, s57, 65536
  s_lshl_b32 s55, s41, 13
  v_add_u32 v15, s55, v1
  s_lshl_b32 s55, s41, 11
  v_add_u32 v11, s55, v1
  s_lshl_b32 s55, s41, 10
  v_add_u32 v12, s55, v1
  v_lshrrev_b32 v6, 4, v0
  v_lshlrev_b32 v6, 2, v6
  v_and_b32 v7, 15, v0
  v_sub_u32 v7, v7, v6
  v_cmp_le_i32 s[92:93], 0, v7
  v_cmp_le_i32 s[94:95], 1, v7
  v_cmp_le_i32 s[96:97], 2, v7
  v_cmp_le_i32 s[98:99], 3, v7
  v_and_b32 v7, 15, v0
  v_lshrrev_b32 v6, 4, v0
  v_cmp_gt_u32 vcc, 8, v7
  v_mov_b32 v250, 0xeeee
  v_mov_b32 v253, 0x4444
  v_cndmask_b32 v250, v250, v253, vcc
  v_lshlrev_b32 v9, 3, v7
  v_lshl_add_u32 v9, v6, 12, v9
  v_and_b32 v252, 7, v0
  v_lshrrev_b32 v253, 5, v0
  v_lshl_add_u32 v252, v252, 1, v253
  v_and_b32 v253, 1, v6
  v_lshlrev_b32 v10, 10, v252
  v_lshl_add_u32 v10, v253, 2, v10
  s_lshl_b32 s55, s40, 5
  s_lshl_b32 s56, s41, 3
  s_add_u32 s55, s55, s56
  v_add_u32 v10, s55, v10
  v_bfrev_b32 v254, 1
  v_cndmask_b32 v10, v254, v10, vcc
  v_lshlrev_b32 v3, 4, v252
  v_lshl_add_u32 v2, v253, 3, v3
  v_add_u32 v3, s57, v3
  s_lshl_b32 s55, s41, 8
  s_add_u32 s55, s55, 8192
  v_add_u32 v2, s55, v2
  v_add_u32 v4, 8192, v12
  v_mov_b32 v252, 0x3f80
  v_and_b32 v253, 2, v7
  v_cmp_eq_u32 s[4:5], 0, v253
  v_mov_b32 v254, 0
  s_nop 0
  v_cndmask_b32 v253, v254, v252, s[4:5]
  v_cndmask_b32 v244, v254, v253, vcc
  v_cndmask_b32 v245, v253, v254, vcc
  v_mov_b32 v246, v244
  v_mov_b32 v247, v245
  v_bfe_u32 v253, v7, 2, 1
  v_and_b32 v254, 1, v7
  v_lshl_add_u32 v253, v253, 1, v254
  v_xor_b32 v254, 1, v253
  v_lshl_add_u32 v253, v254, 2, v253
  v_mul_u32_u24 v5, 0x1111, v253
  v_and_b32 v6, 1, v6
  v_lshlrev_b32 v6, 2, v6
  v_and_b32 v7, 7, v0
  v_sub_u32 v7, v7, v6
  v_mov_b32 v253, 0x3f800000
  v_mov_b32 v248, 0
  v_cmp_eq_u32 vcc, 0, v7
  s_nop 1
  v_cndmask_b32 v248, v248, v252, vcc
  v_cmp_eq_u32 vcc, 1, v7
  s_nop 1
  v_cndmask_b32 v248, v248, v253, vcc
  v_mov_b32 v249, 0
  v_cmp_eq_u32 vcc, 2, v7
  s_nop 1
  v_cndmask_b32 v249, v249, v252, vcc
  v_cmp_eq_u32 vcc, 3, v7
  s_nop 1
  v_cndmask_b32 v249, v249, v253, vcc
  v_mov_b32 v251, 0xff800000
  s_mov_b32 s52, 0x40a1400
  v_mul_u32_u24 v6, 4, v0
  s_mov_b32 s54, 1048576
  s_mov_b32 exec_lo, 0x7f7f7f7f
  s_mov_b32 exec_hi, 0x7f7f7f7f
L_poll_d3_25:
  buffer_load_dword v7, v6, s[8:11], s52 offen sc1
  s_sub_u32 s54, s54, 1
  s_cbranch_scc1 L_fail
  s_waitcnt vmcnt(0)
  v_cmp_gt_u32 vcc, 1, v7
  s_cbranch_vccz L_poll_d3_25_ok
  s_sleep 8
  s_branch L_poll_d3_25
L_poll_d3_25_ok:
  s_mov_b64 exec, -1
  s_mov_b32 s52, 0x40a1500
  v_mul_u32_u24 v6, 4, v0
  s_mov_b32 s54, 1048576
  s_mov_b32 exec_lo, 0x7f7f7f7f
  s_mov_b32 exec_hi, 0x7f7f7f7f
L_poll_d3_26:
  buffer_load_dword v7, v6, s[8:11], s52 offen sc1
  s_sub_u32 s54, s54, 1
  s_cbranch_scc1 L_fail
  s_waitcnt vmcnt(0)
  v_cmp_gt_u32 vcc, 1, v7
  s_cbranch_vccz L_poll_d3_26_ok
  s_sleep 8
  s_branch L_poll_d3_26
L_poll_d3_26_ok:
  s_mov_b64 exec, -1
  s_mov_b32 s52, 0x40a1600
  v_mul_u32_u24 v6, 4, v0
  s_mov_b32 s54, 1048576
  s_mov_b32 exec_lo, 0x7f7f7f7f
  s_mov_b32 exec_hi, 0x7f7f7f7f
L_poll_d3_27:
  buffer_load_dword v7, v6, s[8:11], s52 offen sc1
  s_sub_u32 s54, s54, 1
  s_cbranch_scc1 L_fail
  s_waitcnt vmcnt(0)
  v_cmp_gt_u32 vcc, 1, v7
  s_cbranch_vccz L_poll_d3_27_ok
  s_sleep 8
  s_branch L_poll_d3_27
L_poll_d3_27_ok:
  s_mov_b64 exec, -1
  s_mov_b32 s52, 0x40a1700
  v_mul_u32_u24 v6, 4, v0
  s_mov_b32 s54, 1048576
  s_mov_b32 exec_lo, 0x7f7f7f7f
  s_mov_b32 exec_hi, 0x7f7f7f7f
L_poll_d3_28:
  buffer_load_dword v7, v6, s[8:11], s52 offen sc1
  s_sub_u32 s54, s54, 1
  s_cbranch_scc1 L_fail
  s_waitcnt vmcnt(0)
  v_cmp_gt_u32 vcc, 1, v7
  s_cbranch_vccz L_poll_d3_28_ok
  s_sleep 8
  s_branch L_poll_d3_28
L_poll_d3_28_ok:
  s_mov_b64 exec, -1
  s_lshl_b32 s55, s50, 20
  s_add_u32 s55, s55, 0x5000000
  s_lshl_b32 s45, s41, 17
  s_add_u32 s45, s45, s55
  s_lshl_b32 s56, s40, 7
  s_add_u32 s45, s45, s56
  s_lshl_b32 s47, s40, 14
  s_add_u32 s47, s47, s55
  s_lshl_b32 s56, s41, 12
  s_add_u32 s47, s47, s56
  s_mov_b32 s44, 0
  s_sub_u32 s42, s50, 2
  s_mov_b32 s53, 0x3db504f3
  s_mov_b32 s84, 0x3db504f3
  s_mov_b32 s86, 0x3fb8aa3b
  s_mov_b32 s85, 0x3db504f3
  s_mov_b32 s87, 0x3fb8aa3b
  v_add_u32 v8, s57, v1
  v_and_b32 v14, 0x370, v1
  v_add_u32 v14, 0x10000, v14
  v_and_b32 v13, 0x1f0, v1
  v_add_u32 v13, s57, v13
  v_add_u32 v11, 0x10000, v1
  s_mov_b32 s62, 49152
  s_mov_b32 s61, s47
  s_mov_b32 s60, 0
  s_lshr_b32 s4, s42, 1
  s_lshl_b32 s5, s40, 6
  s_add_u32 s5, s5, s4
  s_lshl_b32 s7, s5, 2
  s_add_u32 s7, s7, s41
  s_lshl_b32 s6, s7, 12
  s_mov_b32 m0, s57
  s_nop 0
  buffer_load_dwordx4 v1, s[8:11], s6 offen offset:0 sc1 lds
  buffer_load_dwordx4 v1, s[8:11], s6 offen offset:1024 sc1 lds
  buffer_load_dwordx4 v1, s[8:11], s6 offen offset:2048 sc1 lds
  buffer_load_dwordx4 v1, s[8:11], s6 offen offset:3072 sc1 lds
  s_and_b32 s6, s42, 1
  s_lshl1_add_u32 s6, s7, s6
  s_lshl_b32 s6, s6, 10
  s_add_u32 s6, s6, 0x2000000
  s_add_u32 m0, s57, 4096
  s_nop 0
  buffer_load_dwordx4 v1, s[8:11], s6 offen offset:0 sc1 lds
  s_lshl_b32 s6, s5, 12
  s_add_u32 s6, s6, 0x4400c00
  s_add_u32 m0, s57, 5120
  s_nop 0
  buffer_load_dwordx4 v1, s[8:11], s6 offen offset:0 sc1 lds
  s_lshl_b32 s6, s42, 2
  s_add_u32 s6, s6, s41
  s_lshl_b32 s6, s6, 12
  s_add_u32 s6, s6, 0x4c00000
  s_add_u32 m0, s57, 6144
  s_nop 0
  buffer_load_dwordx4 v1, s[8:11], s6 offen offset:0 sc1 lds
  buffer_load_dwordx4 v1, s[8:11], s6 offen offset:1024 sc1 lds
  buffer_load_dwordx4 v1, s[8:11], s6 offen offset:2048 sc1 lds
  buffer_load_dwordx4 v1, s[8:11], s6 offen offset:3072 sc1 lds
  s_lshl_b32 s6, s7, 10
  s_add_u32 s6, s6, 0x3800000
  s_add_u32 m0, s57, 10240
  s_nop 0
  buffer_load_dwordx4 v1, s[8:11], s6 offen offset:0 sc1 lds
  s_waitcnt vmcnt(0) lgkmcnt(0)
L_pb_loop:
  s_waitcnt vmcnt(8)
  s_barrier
  ds_read_b128 v[160:163], v11 offset:4096
  ds_read_b128 v[164:167], v11 offset:16384
  ds_read_b128 v[168:171], v11 offset:28672
  ds_read_b128 v[172:175], v11 offset:40960
  ds_read_b128 v[176:179], v11 offset:0
  ds_read_b128 v[180:183], v11 offset:1024
  ds_read_b128 v[184:187], v11 offset:12288
  ds_read_b128 v[188:191], v11 offset:13312
  s_lshr_b32 s49, s42, 1
  s_and_b32 s43, s42, 1
  s_bfe_u32 s48, s44, 0x10001
  s_waitcnt lgkmcnt(2)
  v_mfma_f32_16x16x32_bf16 v[228:231], v[176:179], v[160:163], 0
  v_mfma_f32_16x16x32_bf16 v[232:235], v[180:183], v[160:163], 0
  ds_read_b128 v[176:179], v11 offset:24576
  ds_read_b128 v[180:183], v11 offset:25600
  s_waitcnt lgkmcnt(2)
  v_mfma_f32_16x16x32_bf16 v[228:231], v[184:187], v[164:167], v[228:231]
  v_mfma_f32_16x16x32_bf16 v[232:235], v[188:191], v[164:167], v[232:235]
  ds_read_b128 v[184:187], v11 offset:36864
  ds_read_b128 v[188:191], v11 offset:37888
  s_waitcnt lgkmcnt(2)
  v_mfma_f32_16x16x32_bf16 v[228:231], v[176:179], v[168:171], v[228:231]
  v_mfma_f32_16x16x32_bf16 v[232:235], v[180:183], v[168:171], v[232:235]
  ds_read_b128 v[128:131], v8 offset:6144
  ds_read_b128 v[132:135], v8 offset:7168
  s_waitcnt lgkmcnt(2)
  v_mfma_f32_16x16x32_bf16 v[228:231], v[184:187], v[172:175], v[228:231]
  v_mfma_f32_16x16x32_bf16 v[232:235], v[188:191], v[172:175], v[232:235]
  ds_read_b128 v[136:139], v8 offset:8192
  ds_read_b128 v[140:143], v8 offset:9216
  ds_read_b128 v[220:223], v8 offset:2048
  ds_read_b128 v[224:227], v8 offset:3072
  s_waitcnt lgkmcnt(4)
  v_mfma_f32_16x16x32_bf16 v[240:243], v[112:115], v[128:131], 0
  buffer_load_dwordx4 v[192:195], v1, s[8:11], s61 offen offset:0 sc1
  v_mfma_f32_16x16x32_bf16 v[240:243], v[116:119], v[132:135], v[240:243]
  buffer_load_dwordx4 v[196:199], v1, s[8:11], s61 offen offset:1024 sc1
  s_waitcnt lgkmcnt(2)
  v_mfma_f32_16x16x32_bf16 v[240:243], v[120:123], v[136:139], v[240:243]
  buffer_load_dwordx4 v[200:203], v1, s[8:11], s61 offen offset:2048 sc1
  v_mfma_f32_16x16x32_bf16 v[240:243], v[124:127], v[140:143], v[240:243]
  buffer_load_dwordx4 v[204:207], v1, s[8:11], s61 offen offset:3072 sc1
  v_cvt_pk_bf16_f32 v229, v228, v229
  v_lshlrev_b32 v228, 16, v229
  v_and_b32 v229, 0xffff0000, v229
  v_cvt_pk_bf16_f32 v231, v230, v231
  v_lshlrev_b32 v230, 16, v231
  v_and_b32 v231, 0xffff0000, v231
  v_cvt_pk_bf16_f32 v233, v232, v233
  v_lshlrev_b32 v232, 16, v233
  v_and_b32 v233, 0xffff0000, v233
  v_cvt_pk_bf16_f32 v235, v234, v235
  v_lshlrev_b32 v234, 16, v235
  v_and_b32 v235, 0xffff0000, v235
  v_mul_f32 v228, s53, v228
  v_mul_f32 v229, s53, v229
  v_mul_f32 v230, s53, v230
  v_mul_f32 v231, s53, v231
  v_mul_f32 v232, s53, v232
  v_mul_f32 v233, s53, v233
  v_mul_f32 v234, s53, v234
  v_mul_f32 v235, s53, v235
  v_cvt_pk_bf16_f32 v229, v228, v229
  v_lshlrev_b32 v228, 16, v229
  v_and_b32 v229, 0xffff0000, v229
  v_cvt_pk_bf16_f32 v231, v230, v231
  v_lshlrev_b32 v230, 16, v231
  v_and_b32 v231, 0xffff0000, v231
  v_cvt_pk_bf16_f32 v233, v232, v233
  v_lshlrev_b32 v232, 16, v233
  v_and_b32 v233, 0xffff0000, v233
  v_cvt_pk_bf16_f32 v235, v234, v235
  v_lshlrev_b32 v234, 16, v235
  v_and_b32 v235, 0xffff0000, v235
  ds_write_b128 v4, v[240:243]
  s_cmp_eq_u32 s43, 1
  s_cbranch_scc1 L_pb_t1_29
  v_cndmask_b32 v228, v251, v228, s[92:93]
  v_mov_b32 v232, v251
  v_cndmask_b32 v229, v251, v229, s[94:95]
  v_mov_b32 v233, v251
  v_cndmask_b32 v230, v251, v230, s[96:97]
  v_mov_b32 v234, v251
  v_cndmask_b32 v231, v251, v231, s[98:99]
  v_mov_b32 v235, v251
  s_branch L_pb_tj_30
L_pb_t1_29:
  v_cndmask_b32 v232, v251, v232, s[92:93]
  v_cndmask_b32 v233, v251, v233, s[94:95]
  v_cndmask_b32 v234, v251, v234, s[96:97]
  v_cndmask_b32 v235, v251, v235, s[98:99]
L_pb_tj_30:
  v_max3_f32 v7, v228, v229, v230
  v_max3_f32 v253, v231, v232, v233
  v_max3_f32 v7, v7, v234, v235
  v_max_f32 v7, v7, v253
  v_mov_b32 v253, v7
  s_nop 1
  v_permlane16_swap_b32 v7, v253
  v_max_f32 v7, v7, v253
  v_mov_b32 v253, v7
  s_nop 1
  v_permlane32_swap_b32 v7, v253
  v_max_f32 v7, v7, v253
  s_cmp_eq_u32 s44, 0
  s_waitcnt vmcnt(0)
  s_cbranch_scc1 L_pb_nored
  v_mov_b64 v[144:145], 0
  v_mov_b64 v[146:147], 0
  s_mov_b32 s54, 1048576
  s_branch L_pb_wa
  s_mov_b64 vcc, -1
L_pb_ra:
  s_mov_b64 exec, vcc
  buffer_load_dwordx4 v[192:195], v1, s[8:11], s61 offen offset:0 sc1
  buffer_load_dwordx4 v[196:199], v1, s[8:11], s61 offen offset:1024 sc1
  buffer_load_dwordx4 v[200:203], v1, s[8:11], s61 offen offset:2048 sc1
  buffer_load_dwordx4 v[204:207], v1, s[8:11], s61 offen offset:3072 sc1
  s_sub_u32 s54, s54, 1
  s_cbranch_scc1 L_fail
  s_waitcnt vmcnt(0)
L_pb_wa:
  v_bitop3_b32 v148, v192, v194, s58 bitop3:0x7e
  v_bitop3_b32 v149, v196, v198, s58 bitop3:0x7e
  v_bitop3_b32 v150, v200, v202, s58 bitop3:0x7e
  v_bitop3_b32 v151, v204, v206, s58 bitop3:0x7e
  v_or3_b32 v148, v148, v149, v150
  v_bitop3_b32 v148, v148, v151, 1 bitop3:0xa8
  v_cmp_ne_u32 vcc, 0, v148
  s_cbranch_vccnz L_pb_ra
  s_mov_b64 exec, -1
  v_smfmac_f32_16x16x64_bf16 v[144:147], v[244:247], v[192:199], v5
  v_smfmac_f32_16x16x64_bf16 v[144:147], v[244:247], v[200:207], v5
  s_nop 7
  v_add_f32_dpp v144, v144, v144 row_ror:8 row_mask:0xf bank_mask:0xf
  v_add_f32_dpp v145, v145, v145 row_ror:8 row_mask:0xf bank_mask:0xf
  v_cvt_pk_bf16_f32 v145, v144, v145
  v_lshlrev_b32 v144, 16, v145
  v_and_b32 v145, 0xffff0000, v145
  v_mul_f32 v144, v144, v238
  v_mul_f32 v145, v145, v238
  v_cvt_pk_bf16_f32 v145, v144, v145
  v_lshlrev_b32 v144, 16, v145
  v_and_b32 v145, 0xffff0000, v145
  v_add_f32 v144, v144, v236
  v_add_f32 v145, v145, v237
  v_cvt_pk_bf16_f32 v144, v144, v145
  buffer_store_dword v144, v10, s[12:15], s59 offen
L_pb_nored:
  s_lshl_b32 s55, s43, 2
  v_add_u32 v253, s55, v3
  ds_read_b32 v238, v253 offset:5120
  ds_read_b32 v239, v253 offset:5128
  s_add_u32 s46, s42, 6
  s_mov_b32 s60, s57
  s_add_u32 s57, s57, s62
  s_cmp_ge_u32 s42, 122
  s_cbranch_scc1 L_pb_nopf
  s_lshr_b32 s4, s46, 1
  s_lshl_b32 s5, s40, 6
  s_add_u32 s5, s5, s4
  s_lshl_b32 s7, s5, 2
  s_add_u32 s7, s7, s41
  s_lshl_b32 s6, s7, 12
  s_mov_b32 m0, s57
  s_nop 0
  buffer_load_dwordx4 v1, s[8:11], s6 offen offset:0 sc1 lds
  buffer_load_dwordx4 v1, s[8:11], s6 offen offset:1024 sc1 lds
  buffer_load_dwordx4 v1, s[8:11], s6 offen offset:2048 sc1 lds
  buffer_load_dwordx4 v1, s[8:11], s6 offen offset:3072 sc1 lds
  s_and_b32 s6, s46, 1
  s_lshl1_add_u32 s6, s7, s6
  s_lshl_b32 s6, s6, 10
  s_add_u32 s6, s6, 0x2000000
  s_add_u32 m0, s57, 4096
  s_nop 0
  buffer_load_dwordx4 v1, s[8:11], s6 offen offset:0 sc1 lds
  s_lshl_b32 s6, s5, 12
  s_add_u32 s6, s6, 0x4400c00
  s_add_u32 m0, s57, 5120
  s_nop 0
  buffer_load_dwordx4 v1, s[8:11], s6 offen offset:0 sc1 lds
  s_lshl_b32 s6, s46, 2
  s_add_u32 s6, s6, s41
  s_lshl_b32 s6, s6, 12
  s_add_u32 s6, s6, 0x4c00000
  s_add_u32 m0, s57, 6144
  s_nop 0
  buffer_load_dwordx4 v1, s[8:11], s6 offen offset:0 sc1 lds
  buffer_load_dwordx4 v1, s[8:11], s6 offen offset:1024 sc1 lds
  buffer_load_dwordx4 v1, s[8:11], s6 offen offset:2048 sc1 lds
  buffer_load_dwordx4 v1, s[8:11], s6 offen offset:3072 sc1 lds
  s_lshl_b32 s6, s7, 10
  s_add_u32 s6, s6, 0x3800000
  s_add_u32 m0, s57, 10240
  s_nop 0
  buffer_load_dwordx4 v1, s[8:11], s6 offen offset:0 sc1 lds
L_pb_nopf:
  ds_read_b128 v[208:211], v8 offset:10240
  s_waitcnt lgkmcnt(0)
  v_max3_u32 v253, v208, v209, v210
  v_max_u32 v253, v253, v211
  v_cmp_eq_u32 vcc, -1, v253
  s_cbranch_vccz L_pb_poll_ok
  s_lshl_b32 s55, s40, 6
  s_add_u32 s55, s55, s49
  s_lshl_b32 s55, s55, 2
  s_add_u32 s55, s55, s41
  s_lshl_b32 s55, s55, 10
  s_add_u32 s55, s55, 0x3800000
  s_add_u32 m0, s60, 10240
  s_mov_b32 s54, 1048576
  s_sub_u32 s56, s55, 4096
  s_cmp_eq_u32 s49, 0
  s_cselect_b32 s56, s55, s56
  s_mov_b32 s52, 0
  s_mov_b64 exec, 1
L_pb_poll:
  buffer_load_dword v253, v1, s[8:11], s56 offen sc1
  s_sub_u32 s54, s54, 1
  s_cbranch_scc1 L_fail
  s_waitcnt vmcnt(0)
  v_cmp_eq_u32 vcc, -1, v253
  s_cbranch_vccz L_pb_poll_a
  s_mov_b32 s52, 1
  s_sleep 6
  s_branch L_pb_poll
L_pb_poll_a:
  s_mov_b64 exec, -1
  s_cmp_eq_u32 s52, 0
  s_cbranch_scc1 L_pb_poll_b
  s_sleep 4
L_pb_poll_b:
  buffer_load_dwordx4 v1, s[8:11], s55 offen offset:0 sc1 lds
  s_sub_u32 s54, s54, 1
  s_cbranch_scc1 L_fail
  s_waitcnt vmcnt(0)
  ds_read_b128 v[208:211], v8 offset:10240
  s_waitcnt lgkmcnt(0)
  v_max3_u32 v253, v208, v209, v210
  v_max_u32 v253, v253, v211
  v_cmp_eq_u32 vcc, -1, v253
  s_cbranch_vccnz L_pb_poll_b
L_pb_poll_ok:
  s_barrier
  ds_read_b64 v[176:177], v14 offset:10240
  ds_read_b64 v[178:179], v14 offset:10368
  ds_read_b64 v[180:181], v14 offset:22528
  ds_read_b64 v[182:183], v14 offset:22656
  ds_read_b64 v[184:185], v14 offset:34816
  ds_read_b64 v[186:187], v14 offset:34944
  ds_read_b64 v[188:189], v14 offset:47104
  ds_read_b64 v[190:191], v14 offset:47232
  ds_read_b64 v[212:213], v13 offset:10248
  ds_read_b64 v[214:215], v13 offset:10760
  ds_read_b64 v[128:129], v2 offset:0
  ds_read_b64 v[130:131], v2 offset:1024
  ds_read_b64 v[132:133], v2 offset:2048
  ds_read_b64 v[134:135], v2 offset:3072
  s_waitcnt lgkmcnt(12)
  v_mfma_f32_16x16x32_bf16 v[192:195], v[176:179], v[160:163], 0
  s_waitcnt lgkmcnt(10)
  v_mfma_f32_16x16x32_bf16 v[192:195], v[180:183], v[164:167], v[192:195]
  s_waitcnt lgkmcnt(8)
  v_mfma_f32_16x16x32_bf16 v[192:195], v[184:187], v[168:171], v[192:195]
  s_waitcnt lgkmcnt(6)
  v_mfma_f32_16x16x32_bf16 v[192:195], v[188:191], v[172:175], v[192:195]
  s_waitcnt lgkmcnt(0)
  v_add_f32 v128, v128, v130
  v_add_f32 v129, v129, v131
  v_add_f32 v132, v132, v134
  v_add_f32 v133, v133, v135
  v_add_f32 v236, v128, v132
  v_add_f32 v237, v129, v133
  s_nop 0
  v_cvt_pk_bf16_f32 v193, v192, v193
  v_lshlrev_b32 v192, 16, v193
  v_and_b32 v193, 0xffff0000, v193
  v_cvt_pk_bf16_f32 v195, v194, v195
  v_lshlrev_b32 v194, 16, v195
  v_and_b32 v195, 0xffff0000, v195
  v_pk_mul_f32 v[192:193], v[192:193], s[84:85]
  v_pk_mul_f32 v[194:195], v[194:195], s[84:85]
  v_cvt_pk_bf16_f32 v193, v192, v193
  v_lshlrev_b32 v192, 16, v193
  v_and_b32 v193, 0xffff0000, v193
  v_cvt_pk_bf16_f32 v195, v194, v195
  v_lshlrev_b32 v194, 16, v195
  v_and_b32 v195, 0xffff0000, v195
  v_max3_f32 v252, v192, v193, v7
  v_max3_f32 v252, v252, v194, v195
  v_mov_b32 v253, v252
  s_nop 1
  v_permlane16_swap_b32 v252, v253
  v_max_f32 v252, v252, v253
  v_mul_f32 v252, s86, v252
  v_pk_fma_f32 v[228:229], v[228:229], s[86:87], v[252:253] op_sel_hi:[1,1,0] neg_lo:[0,0,1] neg_hi:[0,0,1]
  v_pk_fma_f32 v[230:231], v[230:231], s[86:87], v[252:253] op_sel_hi:[1,1,0] neg_lo:[0,0,1] neg_hi:[0,0,1]
  v_pk_fma_f32 v[232:233], v[232:233], s[86:87], v[252:253] op_sel_hi:[1,1,0] neg_lo:[0,0,1] neg_hi:[0,0,1]
  v_pk_fma_f32 v[234:235], v[234:235], s[86:87], v[252:253] op_sel_hi:[1,1,0] neg_lo:[0,0,1] neg_hi:[0,0,1]
  v_pk_fma_f32 v[192:193], v[192:193], s[86:87], v[252:253] op_sel_hi:[1,1,0] neg_lo:[0,0,1] neg_hi:[0,0,1]
  v_pk_fma_f32 v[194:195], v[194:195], s[86:87], v[252:253] op_sel_hi:[1,1,0] neg_lo:[0,0,1] neg_hi:[0,0,1]
  v_exp_f32 v228, v228
  v_exp_f32 v229, v229
  v_exp_f32 v230, v230
  v_exp_f32 v231, v231
  v_exp_f32 v232, v232
  v_exp_f32 v233, v233
  v_exp_f32 v234, v234
  v_exp_f32 v235, v235
  v_exp_f32 v192, v192
  v_exp_f32 v193, v193
  v_exp_f32 v194, v194
  v_exp_f32 v195, v195
  v_pk_add_f32 v[240:241], v[228:229], v[230:231]
  v_pk_add_f32 v[242:243], v[232:233], v[234:235]
  v_pk_add_f32 v[254:255], v[192:193], v[194:195]
  v_pk_add_f32 v[240:241], v[240:241], v[242:243]
  v_add_f32 v254, v254, v255
  v_add_f32 v240, v240, v241
  v_fma_f32 v254, v254, 0.5, v240
  v_mov_b32 v253, v254
  s_nop 1
  v_permlane16_swap_b32 v254, v253
  v_add_f32 v254, v254, v253
  v_mov_b32 v253, v254
  s_nop 1
  v_permlane32_swap_b32 v254, v253
  v_add_f32 v254, v254, v253
  v_rcp_f32 v254, v254
  s_nop 0
  v_pk_mul_f32 v[228:229], v[228:229], v[254:255] op_sel_hi:[1,0]
  v_pk_mul_f32 v[230:231], v[230:231], v[254:255] op_sel_hi:[1,0]
  v_pk_mul_f32 v[232:233], v[232:233], v[254:255] op_sel_hi:[1,0]
  v_pk_mul_f32 v[234:235], v[234:235], v[254:255] op_sel_hi:[1,0]
  v_pk_mul_f32 v[192:193], v[192:193], v[254:255] op_sel_hi:[1,0]
  v_pk_mul_f32 v[194:195], v[194:195], v[254:255] op_sel_hi:[1,0]
  v_cvt_pk_bf16_f32 v240, v228, v229
  v_cvt_pk_bf16_f32 v241, v230, v231
  v_cvt_pk_bf16_f32 v242, v232, v233
  v_cvt_pk_bf16_f32 v243, v234, v235
  v_cvt_pk_bf16_f32 v144, v192, v193
  v_cvt_pk_bf16_f32 v145, v194, v195
  s_mov_b32 exec_lo, 0
  v_mov_b64 v[144:145], 0
  s_mov_b32 exec_lo, -1
  v_mfma_f32_16x16x32_bf16 v[200:203], v[220:223], v[240:243], 0
  v_mfma_f32_16x16x32_bf16 v[204:207], v[224:227], v[240:243], 0
  v_mfma_f32_16x16x16_bf16 v[200:203], v[212:213], v[144:145], v[200:203]
  v_mfma_f32_16x16x16_bf16 v[204:207], v[214:215], v[144:145], v[204:207]
  v_cvt_pk_bf16_f32 v237, v236, v237
  v_lshlrev_b32 v236, 16, v237
  v_and_b32 v237, 0xffff0000, v237
  v_mul_f32 v236, v236, v239
  v_mul_f32 v237, v237, v239
  v_cvt_pk_bf16_f32 v237, v236, v237
  v_lshlrev_b32 v236, 16, v237
  v_and_b32 v237, 0xffff0000, v237
  v_cvt_pk_bf16_f32 v240, v200, v201
  v_cvt_pk_bf16_f32 v241, v202, v203
  v_cvt_pk_bf16_f32 v242, v204, v205
  v_cvt_pk_bf16_f32 v243, v206, v207
  ds_write_b128 v12, v[240:243] offset:20480
  s_waitcnt lgkmcnt(0)
  s_barrier
  ds_read_b128 v[192:195], v1 offset:20480
  ds_read_b128 v[196:199], v1 offset:21504
  ds_read_b128 v[200:203], v1 offset:22528
  ds_read_b128 v[204:207], v1 offset:23552
  s_mov_b32 s55, s45
  s_waitcnt lgkmcnt(3)
  v_mfma_f32_16x16x32_bf16 v[128:131], a[0:3], v[192:195], 0
  s_waitcnt lgkmcnt(2)
  v_mfma_f32_16x16x32_bf16 v[128:131], a[4:7], v[196:199], v[128:131]
  s_waitcnt lgkmcnt(1)
  v_mfma_f32_16x16x32_bf16 v[128:131], a[8:11], v[200:203], v[128:131]
  s_waitcnt lgkmcnt(0)
  v_mfma_f32_16x16x32_bf16 v[128:131], a[12:15], v[204:207], v[128:131]
  v_mfma_f32_16x16x32_bf16 v[132:135], a[16:19], v[192:195], 0
  v_mfma_f32_16x16x32_bf16 v[132:135], a[20:23], v[196:199], v[132:135]
  v_mfma_f32_16x16x32_bf16 v[132:135], a[24:27], v[200:203], v[132:135]
  v_cvt_pk_bf16_f32 v128, v128, v129
  v_cvt_pk_bf16_f32 v129, v130, v131
  v_bfi_b32 v128, 1, s48, v128
  v_mfma_f32_16x16x32_bf16 v[132:135], a[28:31], v[204:207], v[132:135]
  buffer_store_dwordx2 v[128:129], v9, s[8:11], s55 offen
  s_add_u32 s55, s55, 0x4000
  v_mfma_f32_16x16x32_bf16 v[136:139], a[32:35], v[192:195], 0
  v_mfma_f32_16x16x32_bf16 v[136:139], a[36:39], v[196:199], v[136:139]
  v_mfma_f32_16x16x32_bf16 v[136:139], a[40:43], v[200:203], v[136:139]
  v_cvt_pk_bf16_f32 v132, v132, v133
  v_cvt_pk_bf16_f32 v133, v134, v135
  v_bfi_b32 v132, 1, s48, v132
  v_mfma_f32_16x16x32_bf16 v[136:139], a[44:47], v[204:207], v[136:139]
  buffer_store_dwordx2 v[132:133], v9, s[8:11], s55 offen
  s_add_u32 s55, s55, 0x4000
  v_mfma_f32_16x16x32_bf16 v[140:143], a[48:51], v[192:195], 0
  v_mfma_f32_16x16x32_bf16 v[140:143], a[52:55], v[196:199], v[140:143]
  v_mfma_f32_16x16x32_bf16 v[140:143], a[56:59], v[200:203], v[140:143]
  v_cvt_pk_bf16_f32 v136, v136, v137
  v_cvt_pk_bf16_f32 v137, v138, v139
  v_bfi_b32 v136, 1, s48, v136
  v_mfma_f32_16x16x32_bf16 v[140:143], a[60:63], v[204:207], v[140:143]
  buffer_store_dwordx2 v[136:137], v9, s[8:11], s55 offen
  s_add_u32 s55, s55, 0x4000
  v_mfma_f32_16x16x32_bf16 v[144:147], a[64:67], v[192:195], 0
  v_mfma_f32_16x16x32_bf16 v[144:147], a[68:71], v[196:199], v[144:147]
  v_mfma_f32_16x16x32_bf16 v[144:147], a[72:75], v[200:203], v[144:147]
  v_cvt_pk_bf16_f32 v140, v140, v141
  v_cvt_pk_bf16_f32 v141, v142, v143
  v_bfi_b32 v140, 1, s48, v140
  v_mfma_f32_16x16x32_bf16 v[144:147], a[76:79], v[204:207], v[144:147]
  buffer_store_dwordx2 v[140:141], v9, s[8:11], s55 offen
  s_add_u32 s55, s55, 0x4000
  v_mfma_f32_16x16x32_bf16 v[148:151], a[80:83], v[192:195], 0
  v_mfma_f32_16x16x32_bf16 v[148:151], a[84:87], v[196:199], v[148:151]
  v_mfma_f32_16x16x32_bf16 v[148:151], a[88:91], v[200:203], v[148:151]
  v_cvt_pk_bf16_f32 v144, v144, v145
  v_cvt_pk_bf16_f32 v145, v146, v147
  v_bfi_b32 v144, 1, s48, v144
  v_mfma_f32_16x16x32_bf16 v[148:151], a[92:95], v[204:207], v[148:151]
  buffer_store_dwordx2 v[144:145], v9, s[8:11], s55 offen
  s_add_u32 s55, s55, 0x4000
  v_mfma_f32_16x16x32_bf16 v[152:155], a[96:99], v[192:195], 0
  v_mfma_f32_16x16x32_bf16 v[152:155], a[100:103], v[196:199], v[152:155]
  v_mfma_f32_16x16x32_bf16 v[152:155], a[104:107], v[200:203], v[152:155]
  v_cvt_pk_bf16_f32 v148, v148, v149
  v_cvt_pk_bf16_f32 v149, v150, v151
  v_bfi_b32 v148, 1, s48, v148
  v_mfma_f32_16x16x32_bf16 v[152:155], a[108:111], v[204:207], v[152:155]
  buffer_store_dwordx2 v[148:149], v9, s[8:11], s55 offen
  s_add_u32 s55, s55, 0x4000
  v_mfma_f32_16x16x32_bf16 v[156:159], a[112:115], v[192:195], 0
  v_mfma_f32_16x16x32_bf16 v[156:159], a[116:119], v[196:199], v[156:159]
  v_mfma_f32_16x16x32_bf16 v[156:159], a[120:123], v[200:203], v[156:159]
  v_cvt_pk_bf16_f32 v152, v152, v153
  v_cvt_pk_bf16_f32 v153, v154, v155
  v_bfi_b32 v152, 1, s48, v152
  v_mfma_f32_16x16x32_bf16 v[156:159], a[124:127], v[204:207], v[156:159]
  buffer_store_dwordx2 v[152:153], v9, s[8:11], s55 offen
  s_add_u32 s55, s55, 0x4000
  s_mov_b32 s58, s48
  s_mov_b32 s61, s47
  s_lshl_b32 s59, s42, 14
  s_add_u32 s44, s44, 1
  v_add_u32 v8, s62, v8
  v_add_u32 v11, s62, v11
  v_add_u32 v3, s62, v3
  v_add_u32 v14, s62, v14
  v_add_u32 v13, s62, v13
  s_sub_u32 s62, 0, s62
  v_cvt_pk_bf16_f32 v156, v156, v157
  v_cvt_pk_bf16_f32 v157, v158, v159
  v_bfi_b32 v156, 1, s48, v156
  buffer_store_dwordx2 v[156:157], v9, s[8:11], s55 offen
  s_add_u32 s55, s55, 0x4000
  s_xor_b32 s45, s45, 0x80000
  s_xor_b32 s47, s47, 0x80000
  s_add_u32 s42, s42, 6
  s_cmp_lt_u32 s42, 128
  s_cbranch_scc1 L_pb_loop
  s_nop 15
  s_nop 15
  s_nop 15
  v_mov_b64 v[144:145], 0
  v_mov_b64 v[146:147], 0
  s_mov_b32 s54, 1048576
  s_mov_b64 vcc, -1
L_pb_rb:
  s_mov_b64 exec, vcc
  buffer_load_dwordx4 v[192:195], v1, s[8:11], s61 offen offset:0 sc1
  buffer_load_dwordx4 v[196:199], v1, s[8:11], s61 offen offset:1024 sc1
  buffer_load_dwordx4 v[200:203], v1, s[8:11], s61 offen offset:2048 sc1
  buffer_load_dwordx4 v[204:207], v1, s[8:11], s61 offen offset:3072 sc1
  s_sub_u32 s54, s54, 1
  s_cbranch_scc1 L_fail
  s_waitcnt vmcnt(0)
L_pb_wb:
  v_bitop3_b32 v148, v192, v194, s58 bitop3:0x7e
  v_bitop3_b32 v149, v196, v198, s58 bitop3:0x7e
  v_bitop3_b32 v150, v200, v202, s58 bitop3:0x7e
  v_bitop3_b32 v151, v204, v206, s58 bitop3:0x7e
  v_or3_b32 v148, v148, v149, v150
  v_bitop3_b32 v148, v148, v151, 1 bitop3:0xa8
  v_cmp_ne_u32 vcc, 0, v148
  s_cbranch_vccnz L_pb_rb
  s_mov_b64 exec, -1
  v_smfmac_f32_16x16x64_bf16 v[144:147], v[244:247], v[192:199], v5
  v_smfmac_f32_16x16x64_bf16 v[144:147], v[244:247], v[200:207], v5
  s_nop 7
  v_add_f32_dpp v144, v144, v144 row_ror:8 row_mask:0xf bank_mask:0xf
  v_add_f32_dpp v145, v145, v145 row_ror:8 row_mask:0xf bank_mask:0xf
  v_cvt_pk_bf16_f32 v145, v144, v145
  v_lshlrev_b32 v144, 16, v145
  v_and_b32 v145, 0xffff0000, v145
  v_mul_f32 v144, v144, v238
  v_mul_f32 v145, v145, v238
  v_cvt_pk_bf16_f32 v145, v144, v145
  v_lshlrev_b32 v144, 16, v145
  v_and_b32 v145, 0xffff0000, v145
  v_add_f32 v144, v144, v236
  v_add_f32 v145, v145, v237
  v_cvt_pk_bf16_f32 v144, v144, v145
  buffer_store_dword v144, v10, s[12:15], s59 offen
  s_branch L_end
L_fail:
  s_mov_b64 exec, 1
  v_mov_b32 v1, 128
  v_mov_b32 v2, 1
  buffer_atomic_add v2, v1, s[32:35], 0 offen sc1
L_end:
  s_endpgm
.section .rodata,"a"
.p2align 6
.amdhsa_kernel gated_mix__memory_aug_recurrent_mem_tr__sliding_block__prompt_kernel
  .amdhsa_next_free_vgpr 512
  .amdhsa_next_free_sgpr 102
  .amdhsa_accum_offset 256
  .amdhsa_group_segment_fixed_size 0
  .amdhsa_kernarg_size 112
  .amdhsa_user_sgpr_count 2
  .amdhsa_user_sgpr_kernarg_segment_ptr 1
  .amdhsa_system_sgpr_workgroup_id_x 1
.end_amdhsa_kernel
```
